```python
import torch

def _softmax(x, axis=-1):
    return torch.softmax(x, dim=axis)
def _gelu(x):
    return torch.nn.functional.gelu(x, approximate="tanh")
def _silu(x):
    return torch.nn.functional.silu(x)
def _sigmoid(x):
    return torch.sigmoid(x)
def _layernorm(x, axis=-1, eps=1e-5):
    m = x.mean(dim=axis, keepdim=True)
    v = x.var(dim=axis, keepdim=True, unbiased=False)
    return (x - m) / torch.sqrt(v + eps)
def _scatter_add(tgt, idx, src, axis=0):
    return tgt.clone().index_add_(axis, idx, src)
def _segment_sum(src, seg, n):
    out = torch.zeros((n,) + src.shape[1:], dtype=src.dtype)
    return out.index_add_(0, seg, src)
def _pad(x, pw):
    flat = tuple(v for pair in reversed(pw) for v in pair)
    return torch.nn.functional.pad(x, flat)

kernel_name = 'gated_mix__sliding_local_dilated__linear_kernel_hedgehog__prompt'

def setup_inputs():

    _w = (lambda a: (lambda t: t.to(torch.bfloat16) if t.is_floating_point() else t)(torch.as_tensor(a)))
    def _A_setup():
        B, S, D = 1, 2048, 448
        return {
            "x": _w((lambda *s: torch.randn(*s, dtype=torch.bfloat16) * 0.05)(B, S, D)),
            "wqkv": _w((lambda *s: torch.randn(*s, dtype=torch.bfloat16) * 0.8)(D, 3 * D)),
            "wo": _w((lambda *s: torch.randn(*s, dtype=torch.bfloat16) * 0.05)(D, D)),
        }
    _A_in = _A_setup()

    def _B_setup():
        B, S, D, H = 1, 2048, 448, 16
        Dh = D // H
        return {
            "x": _w((lambda *s: torch.randn(*s, dtype=torch.bfloat16) * 0.05)(B, S, D)),
            "wqkv": _w((lambda *s: torch.randn(*s, dtype=torch.bfloat16) * 1.6)(D, 3 * D)),
            "w_phi": _w((lambda *s: torch.randn(*s, dtype=torch.bfloat16) * 1.6)(H, Dh, Dh) * (Dh ** -0.5)),
            "wo": _w((lambda *s: torch.randn(*s, dtype=torch.bfloat16) * 0.2)(D, D)),
        }
    _B_in = _B_setup()

    return {
        "A_x": _A_in["x"],
        "A_wqkv": _A_in["wqkv"],
        "A_wo": _A_in["wo"],
        "B_x": _B_in["x"],
        "B_wqkv": _B_in["wqkv"],
        "B_w_phi": _B_in["w_phi"],
        "B_wo": _B_in["wo"],
        "gate_w": _w((lambda *s: torch.randn(*s, dtype=torch.bfloat16) * 0.05)(448) * 16.0),
    }

def reference(A_x, A_wqkv, A_wo, B_x, B_wqkv, B_w_phi, B_wo, gate_w):
    def _A_ref(x, wqkv, wo):
        B, S, D = x.shape
        H = 16; Dh = D // H
        W, dil = 8, 2
        qkv = (lambda x, *d: x.permute(*d))((x @ wqkv).reshape(B, S, 3, H, Dh), 2, 0, 3, 1, 4)
        q, k, v = qkv[0], qkv[1], qkv[2]
        scale = Dh ** -0.5
        pos = torch.arange(S)
        off = torch.arange(W) * dil
        idx = pos[:, None] - off[None, :]
        mask = idx >= 0
        idx_c = torch.where(mask, idx, 0).reshape(-1)
        kg = k[:, :, idx_c, :].reshape(B, H, S, W, Dh)
        vg = v[:, :, idx_c, :].reshape(B, H, S, W, Dh)
        logits = torch.einsum("bhsd,bhswd->bhsw", q, kg) * scale
        logits = torch.where(mask[None, None, :, :], logits, -1e9)
        attn = _softmax(logits, axis=-1)
        o = torch.einsum("bhsw,bhswd->bhsd", attn, vg)
        return (lambda x, *d: x.permute(*d))(o, 0, 2, 1, 3).reshape(B, S, D) @ wo

    def _B_ref(x, wqkv, w_phi, wo):
        B, S, D = x.shape
        H = 16; Dh = D // H
        qkv = (lambda x, *d: x.permute(*d))((x @ wqkv).reshape(B, S, 3, H, Dh), 2, 0, 3, 1, 4)
        q, k, v = qkv[0], qkv[1], qkv[2]
        pq = torch.einsum("bhsd,hdf->bhsf", q, w_phi)
        pk = torch.einsum("bhsd,hdf->bhsf", k, w_phi)
        phi_q = torch.concatenate([_softmax(pq, axis=-1), _softmax(-pq, axis=-1)], axis=-1)
        phi_k = torch.concatenate([_softmax(pk, axis=-1), _softmax(-pk, axis=-1)], axis=-1)
        kv = torch.einsum("bhsf,bhsd->bhfd", phi_k, v)
        z  = torch.einsum("bhsf->bhf", phi_k)
        num = torch.einsum("bhqf,bhfd->bhqd", phi_q, kv)
        den = torch.einsum("bhqf,bhf->bhq", phi_q, z)[..., None] + 1e-6
        o = num / den
        return (lambda x, *d: x.permute(*d))(o, 0, 2, 1, 3).reshape(B, S, D) @ wo

    x = A_x
    g = _sigmoid((x * gate_w).sum(-1, keepdims=True))
    a = _A_ref(x, A_wqkv, A_wo)
    b = _B_ref(x, B_wqkv, B_w_phi, B_wo)
    return g * a + (1 - g) * b
```

```asm
; @launch grid=(256,1,1) block=(768,1,1) lds=163840
.amdgcn_target "amdgcn-amd-amdhsa--gfx950"
.text
.globl gated_mix__sliding_local_dilated__linear_kernel_hedgehog__prompt_kernel
.p2align 8
.type gated_mix__sliding_local_dilated__linear_kernel_hedgehog__prompt_kernel,@function
gated_mix__sliding_local_dilated__linear_kernel_hedgehog__prompt_kernel:
    s_cmp_ge_u32 s2, 256
    s_cbranch_scc1 L_end
    s_load_dwordx16 s[72:87], s[0:1], 0
    s_load_dwordx4 s[88:91], s[0:1], 64
    s_load_dwordx2 s[92:93], s[0:1], 80
    v_lshrrev_b32 v152, 6, v0
    v_and_b32 v0, 63, v0
    v_readfirstlane_b32 s43, v152
    s_nop 0
    s_add_u32 s43, s43, 8
    s_cmp_ge_u32 s43, 12
    s_cselect_b32 s48, 12, 0
    s_sub_u32 s43, s43, s48
    s_and_b32 s47, s2, 7
    s_lshr_b32 s46, s2, 3
    s_lshr_b32 s42, s46, 4
    s_xor_b32 s42, s42, 1
    s_and_b32 s40, s47, 3
    s_lshl_b32 s40, s40, 2
    s_bfe_u32 s48, s46, 0x20002
    s_add_u32 s40, s40, s48
    s_lshr_b32 s41, s47, 2
    s_lshl_b32 s41, s41, 2
    s_and_b32 s48, s46, 3
    s_add_u32 s41, s41, s48
    s_mul_i32 s48, s46, 37
    s_lshr_b32 s48, s48, 8
    s_lshl_b32 s44, s47, 2
    s_add_u32 s44, s44, s48
    s_mul_i32 s48, s48, 7
    s_sub_u32 s45, s46, s48
    s_lshr_b32 s3, s43, 1
    s_and_b32 s4, s43, 1
    v_and_b32 v1, 15, v0
    v_lshrrev_b32 v2, 4, v0
    v_lshlrev_b32 v3, 4, v0
    s_mov_b32 s96, 0
    s_mov_b32 s66, 0
    s_mov_b32 s67, 0xffff0000
    s_mov_b32 s68, 0x3fb8aa3b
    s_mov_b32 s69, 0x3e41848f
    s_cmp_eq_u32 s42, 0
    s_cbranch_scc1 L_dA
    s_cmp_lt_u32 s43, 8
    s_cbranch_scc1 L_B_main
    s_cmp_eq_u32 s43, 11
    s_cbranch_scc1 L_B_ld3
    s_branch L_B_ld
L_dA:
    s_cmp_lt_u32 s43, 2
    s_cbranch_scc1 L_A_halo
    s_cmp_lt_u32 s43, 8
    s_cbranch_scc1 L_A_main
    s_cmp_eq_u32 s43, 11
    s_cbranch_scc1 L_A_ld3
    s_branch L_A_ld
L_B_ld:
    s_setprio 3
    s_sub_u32 s3, s43, 8
    v_lshrrev_b32 v152, 3, v0
    v_bfe_u32 v153, v0, 4, 2
    s_lshl_b32 s48, s4, 2
    v_or_b32 v153, s48, v153
    v_and_b32 v154, 7, v0
    v_xor_b32 v153, v153, v154
    s_lshl_b32 s47, s40, 7
    s_lshl_b32 s48, s3, 3
    s_add_u32 s47, s47, s48
    v_add_u32 v152, s47, v152
    v_mul_u32_u24 v4, 896, v152
    v_lshl_add_u32 v4, v153, 4, v4
    s_lshl_b32 s48, s3, 6
    v_add_u32 v152, s48, v0
    v_mul_u32_u24 v153, 9363, v152
    v_lshrrev_b32 v153, 16, v153
    v_mul_u32_u24 v154, 7, v153
    v_sub_u32 v154, v152, v154
    v_and_b32 v152, 0x38, v153
    v_and_b32 v155, 1, v153
    v_lshl_add_u32 v152, v155, 2, v152
    v_bfe_u32 v155, v153, 1, 2
    v_add_u32 v152, v152, v155
    v_mul_u32_u24 v5, 2688, v152
    v_lshl_add_u32 v5, v154, 4, v5
    s_mul_i32 s48, s41, 112
    v_add_u32 v5, s48, v5
    s_lshl_b32 s48, s3, 6
    s_add_u32 s48, s48, 256
    v_add_u32 v152, s48, v0
    v_mul_u32_u24 v153, 9363, v152
    v_lshrrev_b32 v153, 16, v153
    v_mul_u32_u24 v154, 7, v153
    v_sub_u32 v154, v152, v154
    v_and_b32 v152, 0x38, v153
    v_and_b32 v155, 1, v153
    v_lshl_add_u32 v152, v155, 2, v152
    v_bfe_u32 v155, v153, 1, 2
    v_add_u32 v152, v152, v155
    v_mul_u32_u24 v6, 2688, v152
    v_lshl_add_u32 v6, v154, 4, v6
    s_mul_i32 s48, s41, 112
    v_add_u32 v6, s48, v6
    s_lshl_b32 s49, s3, 10
    s_waitcnt lgkmcnt(0)
    s_mov_b32 s8, s72
    s_and_b32 s9, s73, 0xffff
    s_mov_b32 s10, 1835008
    s_mov_b32 s11, 0x20000
    s_cmp_eq_u32 s42, 0
    s_cselect_b32 s47, s74, s80
    s_cselect_b32 s48, s75, s81
    s_mov_b32 s12, s47
    s_and_b32 s13, s48, 0xffff
    s_mov_b32 s14, 1204224
    s_mov_b32 s15, 0x20000
    s_add_u32 m0, s49, 0
    s_mov_b32 s47, 0
    buffer_load_dwordx4 v4, s[8:11], s47 offen lds
    s_add_u32 m0, s49, 4096
    s_mov_b32 s47, 28672
    buffer_load_dwordx4 v4, s[8:11], s47 offen lds
    s_add_u32 m0, s49, 8192
    s_mov_b32 s47, 57344
    buffer_load_dwordx4 v4, s[8:11], s47 offen lds
    s_add_u32 m0, s49, 12288
    s_mov_b32 s47, 86016
    buffer_load_dwordx4 v4, s[8:11], s47 offen lds
    s_add_u32 m0, s49, 18432
    s_mov_b32 s47, 896
    buffer_load_dwordx4 v5, s[12:15], s47 offen lds
    s_add_u32 m0, s49, 22528
    s_mov_b32 s47, 896
    buffer_load_dwordx4 v6, s[12:15], s47 offen lds
    s_add_u32 m0, s49, 25600
    s_mov_b32 s47, 1792
    buffer_load_dwordx4 v5, s[12:15], s47 offen lds
    s_add_u32 m0, s49, 29696
    s_mov_b32 s47, 1792
    buffer_load_dwordx4 v6, s[12:15], s47 offen lds
    s_add_u32 m0, s49, 32768
    s_mov_b32 s47, 0
    buffer_load_dwordx4 v5, s[12:15], s47 offen lds
    s_add_u32 m0, s49, 36864
    s_mov_b32 s47, 0
    buffer_load_dwordx4 v6, s[12:15], s47 offen lds
    s_mov_b32 s71, 25088
    s_cmp_eq_u32 s42, 0
    s_cselect_b32 s47, s86, s82
    s_cselect_b32 s48, s87, s83
    s_cselect_b32 s71, 896, s71
    s_mov_b32 s24, s47
    s_and_b32 s25, s48, 0xffff
    s_mov_b32 s26, s71
    s_mov_b32 s27, 0x20000
    s_mov_b32 s16, s92
    s_and_b32 s17, s93, 0xffff
    s_mov_b32 s18, 16777216
    s_mov_b32 s19, 0x20000
    s_mov_b32 s28, s76
    s_and_b32 s29, s77, 0xffff
    s_mov_b32 s30, 401408
    s_mov_b32 s31, 0x20000
    s_mov_b32 s32, s84
    s_and_b32 s33, s85, 0xffff
    s_mov_b32 s34, 401408
    s_mov_b32 s35, 0x20000
    s_mov_b32 s36, s88
    s_and_b32 s37, s89, 0xffff
    s_mov_b32 s38, 1835008
    s_mov_b32 s39, 0x20000
    s_mov_b32 s20, s90
    s_and_b32 s21, s91, 0xffff
    s_mov_b32 s22, 256
    s_mov_b32 s23, 0x20000
    s_add_u32 m0, s49, 39936
    s_mov_b32 s47, 128
    buffer_load_dwordx4 v4, s[8:11], s47 offen lds
    s_add_u32 m0, s49, 44032
    s_mov_b32 s47, 28800
    buffer_load_dwordx4 v4, s[8:11], s47 offen lds
    s_add_u32 m0, s49, 48128
    s_mov_b32 s47, 57472
    buffer_load_dwordx4 v4, s[8:11], s47 offen lds
    s_add_u32 m0, s49, 52224
    s_mov_b32 s47, 86144
    buffer_load_dwordx4 v4, s[8:11], s47 offen lds
    s_add_u32 m0, s49, 58368
    s_mov_b32 s47, 172928
    buffer_load_dwordx4 v5, s[12:15], s47 offen lds
    s_add_u32 m0, s49, 62464
    s_mov_b32 s47, 172928
    buffer_load_dwordx4 v6, s[12:15], s47 offen lds
    s_add_u32 m0, s49, 65536
    s_mov_b32 s47, 173824
    buffer_load_dwordx4 v5, s[12:15], s47 offen lds
    s_add_u32 m0, s49, 69632
    s_mov_b32 s47, 173824
    buffer_load_dwordx4 v6, s[12:15], s47 offen lds
    s_add_u32 m0, s49, 72704
    s_mov_b32 s47, 172032
    buffer_load_dwordx4 v5, s[12:15], s47 offen lds
    s_add_u32 m0, s49, 76800
    s_mov_b32 s47, 172032
    buffer_load_dwordx4 v6, s[12:15], s47 offen lds
    s_barrier
    v_lshrrev_b32 v9, 3, v0
    v_bfe_u32 v153, v0, 4, 2
    v_lshlrev_b32 v153, 1, v153
    v_and_b32 v154, 7, v0
    v_xor_b32 v153, v153, v154
    v_mul_u32_u24 v9, 896, v9
    v_lshl_add_u32 v9, v153, 4, v9
    s_lshl_b32 s48, s45, 7
    s_mul_i32 s71, s3, 7168
    s_add_u32 s48, s48, s71
    s_cmp_ge_u32 s46, 28
    s_cselect_b32 s48, 0x1000000, s48
    v_add_u32 v9, s48, v9
    s_waitcnt vmcnt(10)
    s_barrier
    s_add_u32 m0, s49, 79872
    s_mov_b32 s47, 256
    buffer_load_dwordx4 v4, s[8:11], s47 offen lds
    s_add_u32 m0, s49, 83968
    s_mov_b32 s47, 28928
    buffer_load_dwordx4 v4, s[8:11], s47 offen lds
    s_add_u32 m0, s49, 88064
    s_mov_b32 s47, 57600
    buffer_load_dwordx4 v4, s[8:11], s47 offen lds
    s_add_u32 m0, s49, 92160
    s_mov_b32 s47, 86272
    buffer_load_dwordx4 v4, s[8:11], s47 offen lds
    s_add_u32 m0, s49, 98304
    s_mov_b32 s47, 344960
    buffer_load_dwordx4 v5, s[12:15], s47 offen lds
    s_add_u32 m0, s49, 102400
    s_mov_b32 s47, 344960
    buffer_load_dwordx4 v6, s[12:15], s47 offen lds
    s_add_u32 m0, s49, 105472
    s_mov_b32 s47, 345856
    buffer_load_dwordx4 v5, s[12:15], s47 offen lds
    s_add_u32 m0, s49, 109568
    s_mov_b32 s47, 345856
    buffer_load_dwordx4 v6, s[12:15], s47 offen lds
    s_add_u32 m0, s49, 112640
    s_mov_b32 s47, 344064
    buffer_load_dwordx4 v5, s[12:15], s47 offen lds
    s_add_u32 m0, s49, 116736
    s_mov_b32 s47, 344064
    buffer_load_dwordx4 v6, s[12:15], s47 offen lds
    s_waitcnt vmcnt(10)
    s_barrier
    s_add_u32 m0, s49, 119808
    s_mov_b32 s47, 384
    buffer_load_dwordx4 v4, s[8:11], s47 offen lds
    s_add_u32 m0, s49, 123904
    s_mov_b32 s47, 29056
    buffer_load_dwordx4 v4, s[8:11], s47 offen lds
    s_add_u32 m0, s49, 128000
    s_mov_b32 s47, 57728
    buffer_load_dwordx4 v4, s[8:11], s47 offen lds
    s_add_u32 m0, s49, 132096
    s_mov_b32 s47, 86400
    buffer_load_dwordx4 v4, s[8:11], s47 offen lds
    s_add_u32 m0, s49, 138240
    s_mov_b32 s47, 516992
    buffer_load_dwordx4 v5, s[12:15], s47 offen lds
    s_add_u32 m0, s49, 142336
    s_mov_b32 s47, 516992
    buffer_load_dwordx4 v6, s[12:15], s47 offen lds
    s_add_u32 m0, s49, 145408
    s_mov_b32 s47, 517888
    buffer_load_dwordx4 v5, s[12:15], s47 offen lds
    s_add_u32 m0, s49, 149504
    s_mov_b32 s47, 517888
    buffer_load_dwordx4 v6, s[12:15], s47 offen lds
    s_add_u32 m0, s49, 152576
    s_mov_b32 s47, 516096
    buffer_load_dwordx4 v5, s[12:15], s47 offen lds
    s_add_u32 m0, s49, 156672
    s_mov_b32 s47, 516096
    buffer_load_dwordx4 v6, s[12:15], s47 offen lds
    s_waitcnt vmcnt(10)
    s_barrier
    s_add_u32 m0, s49, 0
    s_mov_b32 s47, 512
    buffer_load_dwordx4 v4, s[8:11], s47 offen lds
    s_add_u32 m0, s49, 4096
    s_mov_b32 s47, 29184
    buffer_load_dwordx4 v4, s[8:11], s47 offen lds
    s_add_u32 m0, s49, 8192
    s_mov_b32 s47, 57856
    buffer_load_dwordx4 v4, s[8:11], s47 offen lds
    s_add_u32 m0, s49, 12288
    s_mov_b32 s47, 86528
    buffer_load_dwordx4 v4, s[8:11], s47 offen lds
    s_add_u32 m0, s49, 18432
    s_mov_b32 s47, 689024
    buffer_load_dwordx4 v5, s[12:15], s47 offen lds
    s_add_u32 m0, s49, 22528
    s_mov_b32 s47, 689024
    buffer_load_dwordx4 v6, s[12:15], s47 offen lds
    s_add_u32 m0, s49, 25600
    s_mov_b32 s47, 689920
    buffer_load_dwordx4 v5, s[12:15], s47 offen lds
    s_add_u32 m0, s49, 29696
    s_mov_b32 s47, 689920
    buffer_load_dwordx4 v6, s[12:15], s47 offen lds
    s_add_u32 m0, s49, 32768
    s_mov_b32 s47, 688128
    buffer_load_dwordx4 v5, s[12:15], s47 offen lds
    s_add_u32 m0, s49, 36864
    s_mov_b32 s47, 688128
    buffer_load_dwordx4 v6, s[12:15], s47 offen lds
    s_waitcnt vmcnt(10)
    s_barrier
    s_add_u32 m0, s49, 39936
    s_mov_b32 s47, 640
    buffer_load_dwordx4 v4, s[8:11], s47 offen lds
    s_add_u32 m0, s49, 44032
    s_mov_b32 s47, 29312
    buffer_load_dwordx4 v4, s[8:11], s47 offen lds
    s_add_u32 m0, s49, 48128
    s_mov_b32 s47, 57984
    buffer_load_dwordx4 v4, s[8:11], s47 offen lds
    s_add_u32 m0, s49, 52224
    s_mov_b32 s47, 86656
    buffer_load_dwordx4 v4, s[8:11], s47 offen lds
    s_add_u32 m0, s49, 58368
    s_mov_b32 s47, 861056
    buffer_load_dwordx4 v5, s[12:15], s47 offen lds
    s_add_u32 m0, s49, 62464
    s_mov_b32 s47, 861056
    buffer_load_dwordx4 v6, s[12:15], s47 offen lds
    s_add_u32 m0, s49, 65536
    s_mov_b32 s47, 861952
    buffer_load_dwordx4 v5, s[12:15], s47 offen lds
    s_add_u32 m0, s49, 69632
    s_mov_b32 s47, 861952
    buffer_load_dwordx4 v6, s[12:15], s47 offen lds
    s_add_u32 m0, s49, 72704
    s_mov_b32 s47, 860160
    buffer_load_dwordx4 v5, s[12:15], s47 offen lds
    s_add_u32 m0, s49, 76800
    s_mov_b32 s47, 860160
    buffer_load_dwordx4 v6, s[12:15], s47 offen lds
    s_waitcnt vmcnt(10)
    s_barrier
    s_add_u32 m0, s49, 79872
    s_mov_b32 s47, 768
    buffer_load_dwordx4 v4, s[8:11], s47 offen lds
    s_add_u32 m0, s49, 83968
    s_mov_b32 s47, 29440
    buffer_load_dwordx4 v4, s[8:11], s47 offen lds
    s_add_u32 m0, s49, 88064
    s_mov_b32 s47, 58112
    buffer_load_dwordx4 v4, s[8:11], s47 offen lds
    s_add_u32 m0, s49, 92160
    s_mov_b32 s47, 86784
    buffer_load_dwordx4 v4, s[8:11], s47 offen lds
    s_add_u32 m0, s49, 98304
    s_mov_b32 s47, 1033088
    buffer_load_dwordx4 v5, s[12:15], s47 offen lds
    s_add_u32 m0, s49, 102400
    s_mov_b32 s47, 1033088
    buffer_load_dwordx4 v6, s[12:15], s47 offen lds
    s_add_u32 m0, s49, 105472
    s_mov_b32 s47, 1033984
    buffer_load_dwordx4 v5, s[12:15], s47 offen lds
    s_add_u32 m0, s49, 109568
    s_mov_b32 s47, 1033984
    buffer_load_dwordx4 v6, s[12:15], s47 offen lds
    s_add_u32 m0, s49, 112640
    s_mov_b32 s47, 1032192
    buffer_load_dwordx4 v5, s[12:15], s47 offen lds
    s_add_u32 m0, s49, 116736
    s_mov_b32 s47, 1032192
    buffer_load_dwordx4 v6, s[12:15], s47 offen lds
    s_waitcnt vmcnt(10)
    s_barrier
    s_waitcnt vmcnt(0)
    s_barrier
    s_barrier
    s_barrier
    s_add_u32 m0, s49, 58368
    s_mov_b32 s47, 0
    buffer_load_dwordx4 v9, s[28:31], s47 offen lds
    s_add_u32 m0, s49, 62464
    s_mov_b32 s47, 28672
    buffer_load_dwordx4 v9, s[28:31], s47 offen lds
    s_add_u32 m0, s49, 66560
    s_mov_b32 s47, 57344
    buffer_load_dwordx4 v9, s[28:31], s47 offen lds
    s_add_u32 m0, s49, 70656
    s_mov_b32 s47, 86016
    buffer_load_dwordx4 v9, s[28:31], s47 offen lds
    s_add_u32 m0, s49, 74752
    s_mov_b32 s47, 114688
    buffer_load_dwordx4 v9, s[28:31], s47 offen lds
    s_add_u32 m0, s49, 78848
    s_mov_b32 s47, 143360
    buffer_load_dwordx4 v9, s[28:31], s47 offen lds
    s_add_u32 m0, s49, 82944
    s_mov_b32 s47, 172032
    buffer_load_dwordx4 v9, s[28:31], s47 offen lds
    s_add_u32 m0, s49, 87040
    s_mov_b32 s47, 200704
    buffer_load_dwordx4 v9, s[28:31], s47 offen lds
    s_add_u32 m0, s49, 91136
    s_mov_b32 s47, 229376
    buffer_load_dwordx4 v9, s[28:31], s47 offen lds
    s_add_u32 m0, s49, 95232
    s_mov_b32 s47, 258048
    buffer_load_dwordx4 v9, s[28:31], s47 offen lds
    s_add_u32 m0, s49, 99328
    s_mov_b32 s47, 286720
    buffer_load_dwordx4 v9, s[28:31], s47 offen lds
    s_add_u32 m0, s49, 103424
    s_mov_b32 s47, 315392
    buffer_load_dwordx4 v9, s[28:31], s47 offen lds
    s_add_u32 m0, s49, 107520
    s_mov_b32 s47, 344064
    buffer_load_dwordx4 v9, s[28:31], s47 offen lds
    s_add_u32 m0, s49, 111616
    s_mov_b32 s47, 372736
    buffer_load_dwordx4 v9, s[28:31], s47 offen lds
    s_barrier
    s_barrier
    s_cmp_ge_u32 s46, 28
    s_cbranch_scc1 L_end
    s_waitcnt vmcnt(0)
    s_barrier
    s_add_u32 m0, s49, 0
    s_mov_b32 s47, 0
    buffer_load_dwordx4 v9, s[32:35], s47 offen lds
    s_add_u32 m0, s49, 4096
    s_mov_b32 s47, 28672
    buffer_load_dwordx4 v9, s[32:35], s47 offen lds
    s_add_u32 m0, s49, 8192
    s_mov_b32 s47, 57344
    buffer_load_dwordx4 v9, s[32:35], s47 offen lds
    s_add_u32 m0, s49, 12288
    s_mov_b32 s47, 86016
    buffer_load_dwordx4 v9, s[32:35], s47 offen lds
    s_add_u32 m0, s49, 16384
    s_mov_b32 s47, 114688
    buffer_load_dwordx4 v9, s[32:35], s47 offen lds
    s_add_u32 m0, s49, 20480
    s_mov_b32 s47, 143360
    buffer_load_dwordx4 v9, s[32:35], s47 offen lds
    s_add_u32 m0, s49, 24576
    s_mov_b32 s47, 172032
    buffer_load_dwordx4 v9, s[32:35], s47 offen lds
    s_add_u32 m0, s49, 28672
    s_mov_b32 s47, 200704
    buffer_load_dwordx4 v9, s[32:35], s47 offen lds
    s_add_u32 m0, s49, 32768
    s_mov_b32 s47, 229376
    buffer_load_dwordx4 v9, s[32:35], s47 offen lds
    s_add_u32 m0, s49, 36864
    s_mov_b32 s47, 258048
    buffer_load_dwordx4 v9, s[32:35], s47 offen lds
    s_add_u32 m0, s49, 40960
    s_mov_b32 s47, 286720
    buffer_load_dwordx4 v9, s[32:35], s47 offen lds
    s_add_u32 m0, s49, 45056
    s_mov_b32 s47, 315392
    buffer_load_dwordx4 v9, s[32:35], s47 offen lds
    s_add_u32 m0, s49, 49152
    s_mov_b32 s47, 344064
    buffer_load_dwordx4 v9, s[32:35], s47 offen lds
    s_add_u32 m0, s49, 53248
    s_mov_b32 s47, 372736
    buffer_load_dwordx4 v9, s[32:35], s47 offen lds
    s_waitcnt vmcnt(0)
    s_barrier
    s_branch L_end
L_B_ld3:
    s_setprio 3
    s_sub_u32 s3, s43, 8
    v_lshrrev_b32 v152, 3, v0
    v_bfe_u32 v153, v0, 4, 2
    s_lshl_b32 s48, s4, 2
    v_or_b32 v153, s48, v153
    v_and_b32 v154, 7, v0
    v_xor_b32 v153, v153, v154
    s_lshl_b32 s47, s40, 7
    s_lshl_b32 s48, s3, 3
    s_add_u32 s47, s47, s48
    v_add_u32 v152, s47, v152
    v_mul_u32_u24 v4, 896, v152
    v_lshl_add_u32 v4, v153, 4, v4
    s_lshl_b32 s48, s3, 6
    v_add_u32 v152, s48, v0
    v_mul_u32_u24 v153, 9363, v152
    v_lshrrev_b32 v153, 16, v153
    v_mul_u32_u24 v154, 7, v153
    v_sub_u32 v154, v152, v154
    v_and_b32 v152, 0x38, v153
    v_and_b32 v155, 1, v153
    v_lshl_add_u32 v152, v155, 2, v152
    v_bfe_u32 v155, v153, 1, 2
    v_add_u32 v152, v152, v155
    v_mul_u32_u24 v5, 2688, v152
    v_lshl_add_u32 v5, v154, 4, v5
    s_mul_i32 s48, s41, 112
    v_add_u32 v5, s48, v5
    s_lshl_b32 s49, s3, 10
    s_waitcnt lgkmcnt(0)
    s_mov_b32 s8, s72
    s_and_b32 s9, s73, 0xffff
    s_mov_b32 s10, 1835008
    s_mov_b32 s11, 0x20000
    s_cmp_eq_u32 s42, 0
    s_cselect_b32 s47, s74, s80
    s_cselect_b32 s48, s75, s81
    s_mov_b32 s12, s47
    s_and_b32 s13, s48, 0xffff
    s_mov_b32 s14, 1204224
    s_mov_b32 s15, 0x20000
    s_add_u32 m0, s49, 0
    s_mov_b32 s47, 0
    buffer_load_dwordx4 v4, s[8:11], s47 offen lds
    s_add_u32 m0, s49, 4096
    s_mov_b32 s47, 28672
    buffer_load_dwordx4 v4, s[8:11], s47 offen lds
    s_add_u32 m0, s49, 8192
    s_mov_b32 s47, 57344
    buffer_load_dwordx4 v4, s[8:11], s47 offen lds
    s_add_u32 m0, s49, 12288
    s_mov_b32 s47, 86016
    buffer_load_dwordx4 v4, s[8:11], s47 offen lds
    s_add_u32 m0, s49, 18432
    s_mov_b32 s47, 896
    buffer_load_dwordx4 v5, s[12:15], s47 offen lds
    s_add_u32 m0, s49, 25600
    s_mov_b32 s47, 1792
    buffer_load_dwordx4 v5, s[12:15], s47 offen lds
    s_add_u32 m0, s49, 32768
    s_mov_b32 s47, 0
    buffer_load_dwordx4 v5, s[12:15], s47 offen lds
    s_mov_b32 s71, 25088
    s_cmp_eq_u32 s42, 0
    s_cselect_b32 s47, s86, s82
    s_cselect_b32 s48, s87, s83
    s_cselect_b32 s71, 896, s71
    s_mov_b32 s24, s47
    s_and_b32 s25, s48, 0xffff
    s_mov_b32 s26, s71
    s_mov_b32 s27, 0x20000
    s_mov_b32 s16, s92
    s_and_b32 s17, s93, 0xffff
    s_mov_b32 s18, 16777216
    s_mov_b32 s19, 0x20000
    s_mov_b32 s28, s76
    s_and_b32 s29, s77, 0xffff
    s_mov_b32 s30, 401408
    s_mov_b32 s31, 0x20000
    s_mov_b32 s32, s84
    s_and_b32 s33, s85, 0xffff
    s_mov_b32 s34, 401408
    s_mov_b32 s35, 0x20000
    s_mov_b32 s36, s88
    s_and_b32 s37, s89, 0xffff
    s_mov_b32 s38, 1835008
    s_mov_b32 s39, 0x20000
    s_mov_b32 s20, s90
    s_and_b32 s21, s91, 0xffff
    s_mov_b32 s22, 256
    s_mov_b32 s23, 0x20000
    s_mul_i32 s48, s41, 3136
    v_add_u32 v152, s48, v3
    s_mov_b32 m0, 159744
    s_mov_b32 s47, 0
    buffer_load_dwordx4 v152, s[24:27], s47 offen lds
    s_mov_b32 m0, 160768
    s_mov_b32 s47, 1024
    buffer_load_dwordx4 v152, s[24:27], s47 offen lds
    s_mov_b32 m0, 161792
    s_mov_b32 s47, 2048
    buffer_load_dwordx4 v152, s[24:27], s47 offen lds
    s_mov_b32 m0, 162816
    s_mov_b32 s47, 3072
    buffer_load_dwordx4 v152, s[24:27], s47 offen lds
    s_add_u32 m0, s49, 39936
    s_mov_b32 s47, 128
    buffer_load_dwordx4 v4, s[8:11], s47 offen lds
    s_add_u32 m0, s49, 44032
    s_mov_b32 s47, 28800
    buffer_load_dwordx4 v4, s[8:11], s47 offen lds
    s_add_u32 m0, s49, 48128
    s_mov_b32 s47, 57472
    buffer_load_dwordx4 v4, s[8:11], s47 offen lds
    s_add_u32 m0, s49, 52224
    s_mov_b32 s47, 86144
    buffer_load_dwordx4 v4, s[8:11], s47 offen lds
    s_add_u32 m0, s49, 58368
    s_mov_b32 s47, 172928
    buffer_load_dwordx4 v5, s[12:15], s47 offen lds
    s_add_u32 m0, s49, 65536
    s_mov_b32 s47, 173824
    buffer_load_dwordx4 v5, s[12:15], s47 offen lds
    s_add_u32 m0, s49, 72704
    s_mov_b32 s47, 172032
    buffer_load_dwordx4 v5, s[12:15], s47 offen lds
    s_barrier
    v_lshrrev_b32 v9, 3, v0
    v_bfe_u32 v153, v0, 4, 2
    v_lshlrev_b32 v153, 1, v153
    v_and_b32 v154, 7, v0
    v_xor_b32 v153, v153, v154
    v_mul_u32_u24 v9, 896, v9
    v_lshl_add_u32 v9, v153, 4, v9
    s_lshl_b32 s48, s45, 7
    s_mul_i32 s71, s3, 7168
    s_add_u32 s48, s48, s71
    s_cmp_ge_u32 s46, 28
    s_cselect_b32 s48, 0x1000000, s48
    v_add_u32 v9, s48, v9
    s_waitcnt vmcnt(11)
    s_barrier
    s_add_u32 m0, s49, 79872
    s_mov_b32 s47, 256
    buffer_load_dwordx4 v4, s[8:11], s47 offen lds
    s_add_u32 m0, s49, 83968
    s_mov_b32 s47, 28928
    buffer_load_dwordx4 v4, s[8:11], s47 offen lds
    s_add_u32 m0, s49, 88064
    s_mov_b32 s47, 57600
    buffer_load_dwordx4 v4, s[8:11], s47 offen lds
    s_add_u32 m0, s49, 92160
    s_mov_b32 s47, 86272
    buffer_load_dwordx4 v4, s[8:11], s47 offen lds
    s_add_u32 m0, s49, 98304
    s_mov_b32 s47, 344960
    buffer_load_dwordx4 v5, s[12:15], s47 offen lds
    s_add_u32 m0, s49, 105472
    s_mov_b32 s47, 345856
    buffer_load_dwordx4 v5, s[12:15], s47 offen lds
    s_add_u32 m0, s49, 112640
    s_mov_b32 s47, 344064
    buffer_load_dwordx4 v5, s[12:15], s47 offen lds
    s_waitcnt vmcnt(7)
    s_barrier
    s_add_u32 m0, s49, 119808
    s_mov_b32 s47, 384
    buffer_load_dwordx4 v4, s[8:11], s47 offen lds
    s_add_u32 m0, s49, 123904
    s_mov_b32 s47, 29056
    buffer_load_dwordx4 v4, s[8:11], s47 offen lds
    s_add_u32 m0, s49, 128000
    s_mov_b32 s47, 57728
    buffer_load_dwordx4 v4, s[8:11], s47 offen lds
    s_add_u32 m0, s49, 132096
    s_mov_b32 s47, 86400
    buffer_load_dwordx4 v4, s[8:11], s47 offen lds
    s_add_u32 m0, s49, 138240
    s_mov_b32 s47, 516992
    buffer_load_dwordx4 v5, s[12:15], s47 offen lds
    s_add_u32 m0, s49, 145408
    s_mov_b32 s47, 517888
    buffer_load_dwordx4 v5, s[12:15], s47 offen lds
    s_add_u32 m0, s49, 152576
    s_mov_b32 s47, 516096
    buffer_load_dwordx4 v5, s[12:15], s47 offen lds
    s_waitcnt vmcnt(7)
    s_barrier
    s_add_u32 m0, s49, 0
    s_mov_b32 s47, 512
    buffer_load_dwordx4 v4, s[8:11], s47 offen lds
    s_add_u32 m0, s49, 4096
    s_mov_b32 s47, 29184
    buffer_load_dwordx4 v4, s[8:11], s47 offen lds
    s_add_u32 m0, s49, 8192
    s_mov_b32 s47, 57856
    buffer_load_dwordx4 v4, s[8:11], s47 offen lds
    s_add_u32 m0, s49, 12288
    s_mov_b32 s47, 86528
    buffer_load_dwordx4 v4, s[8:11], s47 offen lds
    s_add_u32 m0, s49, 18432
    s_mov_b32 s47, 689024
    buffer_load_dwordx4 v5, s[12:15], s47 offen lds
    s_add_u32 m0, s49, 25600
    s_mov_b32 s47, 689920
    buffer_load_dwordx4 v5, s[12:15], s47 offen lds
    s_add_u32 m0, s49, 32768
    s_mov_b32 s47, 688128
    buffer_load_dwordx4 v5, s[12:15], s47 offen lds
    s_waitcnt vmcnt(7)
    s_barrier
    s_add_u32 m0, s49, 39936
    s_mov_b32 s47, 640
    buffer_load_dwordx4 v4, s[8:11], s47 offen lds
    s_add_u32 m0, s49, 44032
    s_mov_b32 s47, 29312
    buffer_load_dwordx4 v4, s[8:11], s47 offen lds
    s_add_u32 m0, s49, 48128
    s_mov_b32 s47, 57984
    buffer_load_dwordx4 v4, s[8:11], s47 offen lds
    s_add_u32 m0, s49, 52224
    s_mov_b32 s47, 86656
    buffer_load_dwordx4 v4, s[8:11], s47 offen lds
    s_add_u32 m0, s49, 58368
    s_mov_b32 s47, 861056
    buffer_load_dwordx4 v5, s[12:15], s47 offen lds
    s_add_u32 m0, s49, 65536
    s_mov_b32 s47, 861952
    buffer_load_dwordx4 v5, s[12:15], s47 offen lds
    s_add_u32 m0, s49, 72704
    s_mov_b32 s47, 860160
    buffer_load_dwordx4 v5, s[12:15], s47 offen lds
    s_waitcnt vmcnt(7)
    s_barrier
    s_add_u32 m0, s49, 79872
    s_mov_b32 s47, 768
    buffer_load_dwordx4 v4, s[8:11], s47 offen lds
    s_add_u32 m0, s49, 83968
    s_mov_b32 s47, 29440
    buffer_load_dwordx4 v4, s[8:11], s47 offen lds
    s_add_u32 m0, s49, 88064
    s_mov_b32 s47, 58112
    buffer_load_dwordx4 v4, s[8:11], s47 offen lds
    s_add_u32 m0, s49, 92160
    s_mov_b32 s47, 86784
    buffer_load_dwordx4 v4, s[8:11], s47 offen lds
    s_add_u32 m0, s49, 98304
    s_mov_b32 s47, 1033088
    buffer_load_dwordx4 v5, s[12:15], s47 offen lds
    s_add_u32 m0, s49, 105472
    s_mov_b32 s47, 1033984
    buffer_load_dwordx4 v5, s[12:15], s47 offen lds
    s_add_u32 m0, s49, 112640
    s_mov_b32 s47, 1032192
    buffer_load_dwordx4 v5, s[12:15], s47 offen lds
    s_waitcnt vmcnt(7)
    s_barrier
    s_waitcnt vmcnt(0)
    s_barrier
    v_and_b32 v152, 31, v0
    v_lshlrev_b32 v152, 2, v152
    s_mov_b32 s70, 0
    s_mov_b32 s48, 0x01010101
L_fl_1:
    buffer_load_dword v153, v152, s[20:23], 0 offen offset:0 sc1
    s_waitcnt vmcnt(0)
    v_cmp_ne_u32 vcc, s48, v153
    s_nop 0
    s_cbranch_vccz L_fld_2
    s_add_u32 s70, s70, 1
    s_cmp_lt_u32 s70, 30000
    s_cbranch_scc0 L_fld_2
    s_sleep 40
    s_branch L_fl_1
L_fld_2:
    s_barrier
    s_barrier
    s_add_u32 m0, s49, 58368
    s_mov_b32 s47, 0
    buffer_load_dwordx4 v9, s[28:31], s47 offen lds
    s_add_u32 m0, s49, 62464
    s_mov_b32 s47, 28672
    buffer_load_dwordx4 v9, s[28:31], s47 offen lds
    s_add_u32 m0, s49, 66560
    s_mov_b32 s47, 57344
    buffer_load_dwordx4 v9, s[28:31], s47 offen lds
    s_add_u32 m0, s49, 70656
    s_mov_b32 s47, 86016
    buffer_load_dwordx4 v9, s[28:31], s47 offen lds
    s_add_u32 m0, s49, 74752
    s_mov_b32 s47, 114688
    buffer_load_dwordx4 v9, s[28:31], s47 offen lds
    s_add_u32 m0, s49, 78848
    s_mov_b32 s47, 143360
    buffer_load_dwordx4 v9, s[28:31], s47 offen lds
    s_add_u32 m0, s49, 82944
    s_mov_b32 s47, 172032
    buffer_load_dwordx4 v9, s[28:31], s47 offen lds
    s_add_u32 m0, s49, 87040
    s_mov_b32 s47, 200704
    buffer_load_dwordx4 v9, s[28:31], s47 offen lds
    s_add_u32 m0, s49, 91136
    s_mov_b32 s47, 229376
    buffer_load_dwordx4 v9, s[28:31], s47 offen lds
    s_add_u32 m0, s49, 95232
    s_mov_b32 s47, 258048
    buffer_load_dwordx4 v9, s[28:31], s47 offen lds
    s_add_u32 m0, s49, 99328
    s_mov_b32 s47, 286720
    buffer_load_dwordx4 v9, s[28:31], s47 offen lds
    s_add_u32 m0, s49, 103424
    s_mov_b32 s47, 315392
    buffer_load_dwordx4 v9, s[28:31], s47 offen lds
    s_add_u32 m0, s49, 107520
    s_mov_b32 s47, 344064
    buffer_load_dwordx4 v9, s[28:31], s47 offen lds
    s_add_u32 m0, s49, 111616
    s_mov_b32 s47, 372736
    buffer_load_dwordx4 v9, s[28:31], s47 offen lds
    s_mov_b32 m0, 115712
    s_mov_b32 s47, 401408
    buffer_load_dwordx4 v9, s[28:31], s47 offen lds
    s_barrier
    v_and_b32 v152, 31, v0
    v_lshlrev_b32 v152, 2, v152
    s_mov_b32 s70, 0
    s_mov_b32 s48, 0x01010101
L_fl_3:
    buffer_load_dword v153, v152, s[20:23], 0 offen offset:128 sc1
    s_waitcnt vmcnt(0)
    v_cmp_ne_u32 vcc, s48, v153
    s_nop 0
    s_cbranch_vccz L_fld_4
    s_add_u32 s70, s70, 1
    s_cmp_lt_u32 s70, 30000
    s_cbranch_scc0 L_fld_4
    s_sleep 40
    s_branch L_fl_3
L_fld_4:
    s_barrier
    s_cmp_ge_u32 s46, 28
    s_cbranch_scc1 L_end
    s_barrier
    s_add_u32 m0, s49, 0
    s_mov_b32 s47, 0
    buffer_load_dwordx4 v9, s[32:35], s47 offen lds
    s_add_u32 m0, s49, 4096
    s_mov_b32 s47, 28672
    buffer_load_dwordx4 v9, s[32:35], s47 offen lds
    s_add_u32 m0, s49, 8192
    s_mov_b32 s47, 57344
    buffer_load_dwordx4 v9, s[32:35], s47 offen lds
    s_add_u32 m0, s49, 12288
    s_mov_b32 s47, 86016
    buffer_load_dwordx4 v9, s[32:35], s47 offen lds
    s_add_u32 m0, s49, 16384
    s_mov_b32 s47, 114688
    buffer_load_dwordx4 v9, s[32:35], s47 offen lds
    s_add_u32 m0, s49, 20480
    s_mov_b32 s47, 143360
    buffer_load_dwordx4 v9, s[32:35], s47 offen lds
    s_add_u32 m0, s49, 24576
    s_mov_b32 s47, 172032
    buffer_load_dwordx4 v9, s[32:35], s47 offen lds
    s_add_u32 m0, s49, 28672
    s_mov_b32 s47, 200704
    buffer_load_dwordx4 v9, s[32:35], s47 offen lds
    s_add_u32 m0, s49, 32768
    s_mov_b32 s47, 229376
    buffer_load_dwordx4 v9, s[32:35], s47 offen lds
    s_add_u32 m0, s49, 36864
    s_mov_b32 s47, 258048
    buffer_load_dwordx4 v9, s[32:35], s47 offen lds
    s_add_u32 m0, s49, 40960
    s_mov_b32 s47, 286720
    buffer_load_dwordx4 v9, s[32:35], s47 offen lds
    s_add_u32 m0, s49, 45056
    s_mov_b32 s47, 315392
    buffer_load_dwordx4 v9, s[32:35], s47 offen lds
    s_add_u32 m0, s49, 49152
    s_mov_b32 s47, 344064
    buffer_load_dwordx4 v9, s[32:35], s47 offen lds
    s_add_u32 m0, s49, 53248
    s_mov_b32 s47, 372736
    buffer_load_dwordx4 v9, s[32:35], s47 offen lds
    s_mov_b32 m0, 57344
    s_mov_b32 s47, 401408
    buffer_load_dwordx4 v9, s[32:35], s47 offen lds
    s_waitcnt vmcnt(0)
    s_barrier
    s_branch L_end
L_A_ld:
    s_setprio 3
    s_sub_u32 s3, s43, 8
    v_lshrrev_b32 v152, 3, v0
    v_bfe_u32 v153, v0, 4, 2
    s_lshl_b32 s48, s4, 2
    v_or_b32 v153, s48, v153
    v_and_b32 v154, 7, v0
    v_xor_b32 v153, v153, v154
    s_lshl_b32 s47, s40, 7
    s_lshl_b32 s48, s3, 3
    s_add_u32 s47, s47, s48
    v_add_u32 v152, s47, v152
    v_mul_u32_u24 v4, 896, v152
    v_lshl_add_u32 v4, v153, 4, v4
    s_lshl_b32 s48, s3, 6
    v_add_u32 v152, s48, v0
    v_mul_u32_u24 v153, 9363, v152
    v_lshrrev_b32 v153, 16, v153
    v_mul_u32_u24 v154, 7, v153
    v_sub_u32 v154, v152, v154
    v_and_b32 v152, 0x38, v153
    v_and_b32 v155, 1, v153
    v_lshl_add_u32 v152, v155, 2, v152
    v_bfe_u32 v155, v153, 1, 2
    v_add_u32 v152, v152, v155
    v_mul_u32_u24 v5, 2688, v152
    v_lshl_add_u32 v5, v154, 4, v5
    s_mul_i32 s48, s41, 112
    v_add_u32 v5, s48, v5
    s_lshl_b32 s48, s3, 6
    s_add_u32 s48, s48, 256
    v_add_u32 v152, s48, v0
    v_mul_u32_u24 v153, 9363, v152
    v_lshrrev_b32 v153, 16, v153
    v_mul_u32_u24 v154, 7, v153
    v_sub_u32 v154, v152, v154
    v_and_b32 v152, 0x38, v153
    v_and_b32 v155, 1, v153
    v_lshl_add_u32 v152, v155, 2, v152
    v_bfe_u32 v155, v153, 1, 2
    v_add_u32 v152, v152, v155
    v_mul_u32_u24 v6, 2688, v152
    v_lshl_add_u32 v6, v154, 4, v6
    s_mul_i32 s48, s41, 112
    v_add_u32 v6, s48, v6
    s_lshl_b32 s49, s3, 10
    s_waitcnt lgkmcnt(0)
    s_mov_b32 s8, s72
    s_and_b32 s9, s73, 0xffff
    s_mov_b32 s10, 1835008
    s_mov_b32 s11, 0x20000
    s_cmp_eq_u32 s42, 0
    s_cselect_b32 s47, s74, s80
    s_cselect_b32 s48, s75, s81
    s_mov_b32 s12, s47
    s_and_b32 s13, s48, 0xffff
    s_mov_b32 s14, 1204224
    s_mov_b32 s15, 0x20000
    s_add_u32 m0, s49, 0
    s_mov_b32 s47, 0
    buffer_load_dwordx4 v4, s[8:11], s47 offen lds
    s_add_u32 m0, s49, 4096
    s_mov_b32 s47, 28672
    buffer_load_dwordx4 v4, s[8:11], s47 offen lds
    s_add_u32 m0, s49, 8192
    s_mov_b32 s47, 57344
    buffer_load_dwordx4 v4, s[8:11], s47 offen lds
    s_add_u32 m0, s49, 12288
    s_mov_b32 s47, 86016
    buffer_load_dwordx4 v4, s[8:11], s47 offen lds
    s_add_u32 m0, s49, 18432
    s_mov_b32 s47, 896
    buffer_load_dwordx4 v5, s[12:15], s47 offen lds
    s_add_u32 m0, s49, 22528
    s_mov_b32 s47, 896
    buffer_load_dwordx4 v6, s[12:15], s47 offen lds
    s_add_u32 m0, s49, 25600
    s_mov_b32 s47, 1792
    buffer_load_dwordx4 v5, s[12:15], s47 offen lds
    s_add_u32 m0, s49, 29696
    s_mov_b32 s47, 1792
    buffer_load_dwordx4 v6, s[12:15], s47 offen lds
    s_add_u32 m0, s49, 32768
    s_mov_b32 s47, 0
    buffer_load_dwordx4 v5, s[12:15], s47 offen lds
    s_add_u32 m0, s49, 36864
    s_mov_b32 s47, 0
    buffer_load_dwordx4 v6, s[12:15], s47 offen lds
    s_mov_b32 s71, 25088
    s_cmp_eq_u32 s42, 0
    s_cselect_b32 s47, s86, s82
    s_cselect_b32 s48, s87, s83
    s_cselect_b32 s71, 896, s71
    s_mov_b32 s24, s47
    s_and_b32 s25, s48, 0xffff
    s_mov_b32 s26, s71
    s_mov_b32 s27, 0x20000
    s_mov_b32 s16, s92
    s_and_b32 s17, s93, 0xffff
    s_mov_b32 s18, 16777216
    s_mov_b32 s19, 0x20000
    s_mov_b32 s28, s76
    s_and_b32 s29, s77, 0xffff
    s_mov_b32 s30, 401408
    s_mov_b32 s31, 0x20000
    s_mov_b32 s32, s84
    s_and_b32 s33, s85, 0xffff
    s_mov_b32 s34, 401408
    s_mov_b32 s35, 0x20000
    s_mov_b32 s36, s88
    s_and_b32 s37, s89, 0xffff
    s_mov_b32 s38, 1835008
    s_mov_b32 s39, 0x20000
    s_mov_b32 s20, s90
    s_and_b32 s21, s91, 0xffff
    s_mov_b32 s22, 256
    s_mov_b32 s23, 0x20000
    s_add_u32 m0, s49, 39936
    s_mov_b32 s47, 128
    buffer_load_dwordx4 v4, s[8:11], s47 offen lds
    s_add_u32 m0, s49, 44032
    s_mov_b32 s47, 28800
    buffer_load_dwordx4 v4, s[8:11], s47 offen lds
    s_add_u32 m0, s49, 48128
    s_mov_b32 s47, 57472
    buffer_load_dwordx4 v4, s[8:11], s47 offen lds
    s_add_u32 m0, s49, 52224
    s_mov_b32 s47, 86144
    buffer_load_dwordx4 v4, s[8:11], s47 offen lds
    s_add_u32 m0, s49, 58368
    s_mov_b32 s47, 172928
    buffer_load_dwordx4 v5, s[12:15], s47 offen lds
    s_add_u32 m0, s49, 62464
    s_mov_b32 s47, 172928
    buffer_load_dwordx4 v6, s[12:15], s47 offen lds
    s_add_u32 m0, s49, 65536
    s_mov_b32 s47, 173824
    buffer_load_dwordx4 v5, s[12:15], s47 offen lds
    s_add_u32 m0, s49, 69632
    s_mov_b32 s47, 173824
    buffer_load_dwordx4 v6, s[12:15], s47 offen lds
    s_add_u32 m0, s49, 72704
    s_mov_b32 s47, 172032
    buffer_load_dwordx4 v5, s[12:15], s47 offen lds
    s_add_u32 m0, s49, 76800
    s_mov_b32 s47, 172032
    buffer_load_dwordx4 v6, s[12:15], s47 offen lds
    s_barrier
    v_lshrrev_b32 v9, 3, v0
    v_bfe_u32 v153, v0, 4, 2
    v_lshlrev_b32 v153, 1, v153
    v_and_b32 v154, 7, v0
    v_xor_b32 v153, v153, v154
    v_mul_u32_u24 v9, 896, v9
    v_lshl_add_u32 v9, v153, 4, v9
    s_lshl_b32 s48, s45, 7
    s_mul_i32 s71, s3, 7168
    s_add_u32 s48, s48, s71
    s_cmp_ge_u32 s46, 28
    s_cselect_b32 s48, 0x1000000, s48
    v_add_u32 v9, s48, v9
    s_waitcnt vmcnt(10)
    s_barrier
    s_add_u32 m0, s49, 79872
    s_mov_b32 s47, 256
    buffer_load_dwordx4 v4, s[8:11], s47 offen lds
    s_add_u32 m0, s49, 83968
    s_mov_b32 s47, 28928
    buffer_load_dwordx4 v4, s[8:11], s47 offen lds
    s_add_u32 m0, s49, 88064
    s_mov_b32 s47, 57600
    buffer_load_dwordx4 v4, s[8:11], s47 offen lds
    s_add_u32 m0, s49, 92160
    s_mov_b32 s47, 86272
    buffer_load_dwordx4 v4, s[8:11], s47 offen lds
    s_add_u32 m0, s49, 98304
    s_mov_b32 s47, 344960
    buffer_load_dwordx4 v5, s[12:15], s47 offen lds
    s_add_u32 m0, s49, 102400
    s_mov_b32 s47, 344960
    buffer_load_dwordx4 v6, s[12:15], s47 offen lds
    s_add_u32 m0, s49, 105472
    s_mov_b32 s47, 345856
    buffer_load_dwordx4 v5, s[12:15], s47 offen lds
    s_add_u32 m0, s49, 109568
    s_mov_b32 s47, 345856
    buffer_load_dwordx4 v6, s[12:15], s47 offen lds
    s_add_u32 m0, s49, 112640
    s_mov_b32 s47, 344064
    buffer_load_dwordx4 v5, s[12:15], s47 offen lds
    s_add_u32 m0, s49, 116736
    s_mov_b32 s47, 344064
    buffer_load_dwordx4 v6, s[12:15], s47 offen lds
    s_waitcnt vmcnt(10)
    s_barrier
    s_add_u32 m0, s49, 119808
    s_mov_b32 s47, 384
    buffer_load_dwordx4 v4, s[8:11], s47 offen lds
    s_add_u32 m0, s49, 123904
    s_mov_b32 s47, 29056
    buffer_load_dwordx4 v4, s[8:11], s47 offen lds
    s_add_u32 m0, s49, 128000
    s_mov_b32 s47, 57728
    buffer_load_dwordx4 v4, s[8:11], s47 offen lds
    s_add_u32 m0, s49, 132096
    s_mov_b32 s47, 86400
    buffer_load_dwordx4 v4, s[8:11], s47 offen lds
    s_add_u32 m0, s49, 138240
    s_mov_b32 s47, 516992
    buffer_load_dwordx4 v5, s[12:15], s47 offen lds
    s_add_u32 m0, s49, 142336
    s_mov_b32 s47, 516992
    buffer_load_dwordx4 v6, s[12:15], s47 offen lds
    s_add_u32 m0, s49, 145408
    s_mov_b32 s47, 517888
    buffer_load_dwordx4 v5, s[12:15], s47 offen lds
    s_add_u32 m0, s49, 149504
    s_mov_b32 s47, 517888
    buffer_load_dwordx4 v6, s[12:15], s47 offen lds
    s_add_u32 m0, s49, 152576
    s_mov_b32 s47, 516096
    buffer_load_dwordx4 v5, s[12:15], s47 offen lds
    s_add_u32 m0, s49, 156672
    s_mov_b32 s47, 516096
    buffer_load_dwordx4 v6, s[12:15], s47 offen lds
    s_waitcnt vmcnt(10)
    s_barrier
    s_add_u32 m0, s49, 0
    s_mov_b32 s47, 512
    buffer_load_dwordx4 v4, s[8:11], s47 offen lds
    s_add_u32 m0, s49, 4096
    s_mov_b32 s47, 29184
    buffer_load_dwordx4 v4, s[8:11], s47 offen lds
    s_add_u32 m0, s49, 8192
    s_mov_b32 s47, 57856
    buffer_load_dwordx4 v4, s[8:11], s47 offen lds
    s_add_u32 m0, s49, 12288
    s_mov_b32 s47, 86528
    buffer_load_dwordx4 v4, s[8:11], s47 offen lds
    s_add_u32 m0, s49, 18432
    s_mov_b32 s47, 689024
    buffer_load_dwordx4 v5, s[12:15], s47 offen lds
    s_add_u32 m0, s49, 22528
    s_mov_b32 s47, 689024
    buffer_load_dwordx4 v6, s[12:15], s47 offen lds
    s_add_u32 m0, s49, 25600
    s_mov_b32 s47, 689920
    buffer_load_dwordx4 v5, s[12:15], s47 offen lds
    s_add_u32 m0, s49, 29696
    s_mov_b32 s47, 689920
    buffer_load_dwordx4 v6, s[12:15], s47 offen lds
    s_add_u32 m0, s49, 32768
    s_mov_b32 s47, 688128
    buffer_load_dwordx4 v5, s[12:15], s47 offen lds
    s_add_u32 m0, s49, 36864
    s_mov_b32 s47, 688128
    buffer_load_dwordx4 v6, s[12:15], s47 offen lds
    s_waitcnt vmcnt(10)
    s_barrier
    s_add_u32 m0, s49, 39936
    s_mov_b32 s47, 640
    buffer_load_dwordx4 v4, s[8:11], s47 offen lds
    s_add_u32 m0, s49, 44032
    s_mov_b32 s47, 29312
    buffer_load_dwordx4 v4, s[8:11], s47 offen lds
    s_add_u32 m0, s49, 48128
    s_mov_b32 s47, 57984
    buffer_load_dwordx4 v4, s[8:11], s47 offen lds
    s_add_u32 m0, s49, 52224
    s_mov_b32 s47, 86656
    buffer_load_dwordx4 v4, s[8:11], s47 offen lds
    s_add_u32 m0, s49, 58368
    s_mov_b32 s47, 861056
    buffer_load_dwordx4 v5, s[12:15], s47 offen lds
    s_add_u32 m0, s49, 62464
    s_mov_b32 s47, 861056
    buffer_load_dwordx4 v6, s[12:15], s47 offen lds
    s_add_u32 m0, s49, 65536
    s_mov_b32 s47, 861952
    buffer_load_dwordx4 v5, s[12:15], s47 offen lds
    s_add_u32 m0, s49, 69632
    s_mov_b32 s47, 861952
    buffer_load_dwordx4 v6, s[12:15], s47 offen lds
    s_add_u32 m0, s49, 72704
    s_mov_b32 s47, 860160
    buffer_load_dwordx4 v5, s[12:15], s47 offen lds
    s_add_u32 m0, s49, 76800
    s_mov_b32 s47, 860160
    buffer_load_dwordx4 v6, s[12:15], s47 offen lds
    s_waitcnt vmcnt(10)
    s_barrier
    s_add_u32 m0, s49, 79872
    s_mov_b32 s47, 768
    buffer_load_dwordx4 v4, s[8:11], s47 offen lds
    s_add_u32 m0, s49, 83968
    s_mov_b32 s47, 29440
    buffer_load_dwordx4 v4, s[8:11], s47 offen lds
    s_add_u32 m0, s49, 88064
    s_mov_b32 s47, 58112
    buffer_load_dwordx4 v4, s[8:11], s47 offen lds
    s_add_u32 m0, s49, 92160
    s_mov_b32 s47, 86784
    buffer_load_dwordx4 v4, s[8:11], s47 offen lds
    s_add_u32 m0, s49, 98304
    s_mov_b32 s47, 1033088
    buffer_load_dwordx4 v5, s[12:15], s47 offen lds
    s_add_u32 m0, s49, 102400
    s_mov_b32 s47, 1033088
    buffer_load_dwordx4 v6, s[12:15], s47 offen lds
    s_add_u32 m0, s49, 105472
    s_mov_b32 s47, 1033984
    buffer_load_dwordx4 v5, s[12:15], s47 offen lds
    s_add_u32 m0, s49, 109568
    s_mov_b32 s47, 1033984
    buffer_load_dwordx4 v6, s[12:15], s47 offen lds
    s_add_u32 m0, s49, 112640
    s_mov_b32 s47, 1032192
    buffer_load_dwordx4 v5, s[12:15], s47 offen lds
    s_add_u32 m0, s49, 116736
    s_mov_b32 s47, 1032192
    buffer_load_dwordx4 v6, s[12:15], s47 offen lds
    s_waitcnt vmcnt(10)
    s_barrier
    s_waitcnt vmcnt(0)
    s_barrier
    s_barrier
    s_barrier
    s_barrier
    s_add_u32 m0, s49, 58368
    s_mov_b32 s47, 0
    buffer_load_dwordx4 v9, s[28:31], s47 offen lds
    s_add_u32 m0, s49, 62464
    s_mov_b32 s47, 28672
    buffer_load_dwordx4 v9, s[28:31], s47 offen lds
    s_add_u32 m0, s49, 66560
    s_mov_b32 s47, 57344
    buffer_load_dwordx4 v9, s[28:31], s47 offen lds
    s_add_u32 m0, s49, 70656
    s_mov_b32 s47, 86016
    buffer_load_dwordx4 v9, s[28:31], s47 offen lds
    s_add_u32 m0, s49, 74752
    s_mov_b32 s47, 114688
    buffer_load_dwordx4 v9, s[28:31], s47 offen lds
    s_add_u32 m0, s49, 78848
    s_mov_b32 s47, 143360
    buffer_load_dwordx4 v9, s[28:31], s47 offen lds
    s_add_u32 m0, s49, 82944
    s_mov_b32 s47, 172032
    buffer_load_dwordx4 v9, s[28:31], s47 offen lds
    s_add_u32 m0, s49, 87040
    s_mov_b32 s47, 200704
    buffer_load_dwordx4 v9, s[28:31], s47 offen lds
    s_add_u32 m0, s49, 91136
    s_mov_b32 s47, 229376
    buffer_load_dwordx4 v9, s[28:31], s47 offen lds
    s_add_u32 m0, s49, 95232
    s_mov_b32 s47, 258048
    buffer_load_dwordx4 v9, s[28:31], s47 offen lds
    s_add_u32 m0, s49, 99328
    s_mov_b32 s47, 286720
    buffer_load_dwordx4 v9, s[28:31], s47 offen lds
    s_add_u32 m0, s49, 103424
    s_mov_b32 s47, 315392
    buffer_load_dwordx4 v9, s[28:31], s47 offen lds
    s_add_u32 m0, s49, 107520
    s_mov_b32 s47, 344064
    buffer_load_dwordx4 v9, s[28:31], s47 offen lds
    s_add_u32 m0, s49, 111616
    s_mov_b32 s47, 372736
    buffer_load_dwordx4 v9, s[28:31], s47 offen lds
    s_add_u32 m0, s49, 0
    s_mov_b32 s47, 0
    buffer_load_dwordx4 v9, s[32:35], s47 offen lds
    s_add_u32 m0, s49, 4096
    s_mov_b32 s47, 28672
    buffer_load_dwordx4 v9, s[32:35], s47 offen lds
    s_add_u32 m0, s49, 8192
    s_mov_b32 s47, 57344
    buffer_load_dwordx4 v9, s[32:35], s47 offen lds
    s_add_u32 m0, s49, 12288
    s_mov_b32 s47, 86016
    buffer_load_dwordx4 v9, s[32:35], s47 offen lds
    s_add_u32 m0, s49, 16384
    s_mov_b32 s47, 114688
    buffer_load_dwordx4 v9, s[32:35], s47 offen lds
    s_add_u32 m0, s49, 20480
    s_mov_b32 s47, 143360
    buffer_load_dwordx4 v9, s[32:35], s47 offen lds
    s_add_u32 m0, s49, 24576
    s_mov_b32 s47, 172032
    buffer_load_dwordx4 v9, s[32:35], s47 offen lds
    s_add_u32 m0, s49, 28672
    s_mov_b32 s47, 200704
    buffer_load_dwordx4 v9, s[32:35], s47 offen lds
    s_add_u32 m0, s49, 32768
    s_mov_b32 s47, 229376
    buffer_load_dwordx4 v9, s[32:35], s47 offen lds
    s_add_u32 m0, s49, 36864
    s_mov_b32 s47, 258048
    buffer_load_dwordx4 v9, s[32:35], s47 offen lds
    s_add_u32 m0, s49, 40960
    s_mov_b32 s47, 286720
    buffer_load_dwordx4 v9, s[32:35], s47 offen lds
    s_add_u32 m0, s49, 45056
    s_mov_b32 s47, 315392
    buffer_load_dwordx4 v9, s[32:35], s47 offen lds
    s_add_u32 m0, s49, 49152
    s_mov_b32 s47, 344064
    buffer_load_dwordx4 v9, s[32:35], s47 offen lds
    s_add_u32 m0, s49, 53248
    s_mov_b32 s47, 372736
    buffer_load_dwordx4 v9, s[32:35], s47 offen lds
    s_cmp_ge_u32 s46, 28
    s_cbranch_scc1 L_end
    s_waitcnt vmcnt(14)
    s_barrier
    s_waitcnt vmcnt(0)
    s_barrier
    s_branch L_end
L_A_ld3:
    s_setprio 3
    s_sub_u32 s3, s43, 8
    v_lshrrev_b32 v152, 3, v0
    v_bfe_u32 v153, v0, 4, 2
    s_lshl_b32 s48, s4, 2
    v_or_b32 v153, s48, v153
    v_and_b32 v154, 7, v0
    v_xor_b32 v153, v153, v154
    s_lshl_b32 s47, s40, 7
    s_lshl_b32 s48, s3, 3
    s_add_u32 s47, s47, s48
    v_add_u32 v152, s47, v152
    v_mul_u32_u24 v4, 896, v152
    v_lshl_add_u32 v4, v153, 4, v4
    s_lshl_b32 s48, s3, 6
    v_add_u32 v152, s48, v0
    v_mul_u32_u24 v153, 9363, v152
    v_lshrrev_b32 v153, 16, v153
    v_mul_u32_u24 v154, 7, v153
    v_sub_u32 v154, v152, v154
    v_and_b32 v152, 0x38, v153
    v_and_b32 v155, 1, v153
    v_lshl_add_u32 v152, v155, 2, v152
    v_bfe_u32 v155, v153, 1, 2
    v_add_u32 v152, v152, v155
    v_mul_u32_u24 v5, 2688, v152
    v_lshl_add_u32 v5, v154, 4, v5
    s_mul_i32 s48, s41, 112
    v_add_u32 v5, s48, v5
    s_lshl_b32 s49, s3, 10
    v_subrev_u32 v8, 28672, v4
    v_xor_b32 v7, 64, v4
    v_subrev_u32 v7, 35840, v7
    s_waitcnt lgkmcnt(0)
    s_mov_b32 s8, s72
    s_and_b32 s9, s73, 0xffff
    s_mov_b32 s10, 1835008
    s_mov_b32 s11, 0x20000
    s_cmp_eq_u32 s42, 0
    s_cselect_b32 s47, s74, s80
    s_cselect_b32 s48, s75, s81
    s_mov_b32 s12, s47
    s_and_b32 s13, s48, 0xffff
    s_mov_b32 s14, 1204224
    s_mov_b32 s15, 0x20000
    s_add_u32 m0, s49, 0
    s_mov_b32 s47, 0
    buffer_load_dwordx4 v4, s[8:11], s47 offen lds
    s_add_u32 m0, s49, 4096
    s_mov_b32 s47, 28672
    buffer_load_dwordx4 v4, s[8:11], s47 offen lds
    s_add_u32 m0, s49, 8192
    s_mov_b32 s47, 57344
    buffer_load_dwordx4 v4, s[8:11], s47 offen lds
    s_add_u32 m0, s49, 12288
    s_mov_b32 s47, 86016
    buffer_load_dwordx4 v4, s[8:11], s47 offen lds
    s_add_u32 m0, s49, 18432
    s_mov_b32 s47, 896
    buffer_load_dwordx4 v5, s[12:15], s47 offen lds
    s_add_u32 m0, s49, 25600
    s_mov_b32 s47, 1792
    buffer_load_dwordx4 v5, s[12:15], s47 offen lds
    s_add_u32 m0, s49, 32768
    s_mov_b32 s47, 0
    buffer_load_dwordx4 v5, s[12:15], s47 offen lds
    s_mov_b32 m0, 16384
    s_mov_b32 s47, 0
    buffer_load_dwordx4 v7, s[8:11], s47 offen lds
    s_mov_b32 m0, 17408
    s_mov_b32 s47, 0
    buffer_load_dwordx4 v8, s[8:11], s47 offen lds
    s_mov_b32 s71, 25088
    s_cmp_eq_u32 s42, 0
    s_cselect_b32 s47, s86, s82
    s_cselect_b32 s48, s87, s83
    s_cselect_b32 s71, 896, s71
    s_mov_b32 s24, s47
    s_and_b32 s25, s48, 0xffff
    s_mov_b32 s26, s71
    s_mov_b32 s27, 0x20000
    s_mov_b32 s16, s92
    s_and_b32 s17, s93, 0xffff
    s_mov_b32 s18, 16777216
    s_mov_b32 s19, 0x20000
    s_mov_b32 s28, s76
    s_and_b32 s29, s77, 0xffff
    s_mov_b32 s30, 401408
    s_mov_b32 s31, 0x20000
    s_mov_b32 s32, s84
    s_and_b32 s33, s85, 0xffff
    s_mov_b32 s34, 401408
    s_mov_b32 s35, 0x20000
    s_mov_b32 s36, s88
    s_and_b32 s37, s89, 0xffff
    s_mov_b32 s38, 1835008
    s_mov_b32 s39, 0x20000
    s_mov_b32 s20, s90
    s_and_b32 s21, s91, 0xffff
    s_mov_b32 s22, 256
    s_mov_b32 s23, 0x20000
    s_mov_b32 m0, 159744
    s_nop 0
    buffer_load_dwordx4 v3, s[24:27], 0 offen lds
    s_add_u32 m0, s49, 39936
    s_mov_b32 s47, 128
    buffer_load_dwordx4 v4, s[8:11], s47 offen lds
    s_add_u32 m0, s49, 44032
    s_mov_b32 s47, 28800
    buffer_load_dwordx4 v4, s[8:11], s47 offen lds
    s_add_u32 m0, s49, 48128
    s_mov_b32 s47, 57472
    buffer_load_dwordx4 v4, s[8:11], s47 offen lds
    s_add_u32 m0, s49, 52224
    s_mov_b32 s47, 86144
    buffer_load_dwordx4 v4, s[8:11], s47 offen lds
    s_add_u32 m0, s49, 58368
    s_mov_b32 s47, 172928
    buffer_load_dwordx4 v5, s[12:15], s47 offen lds
    s_add_u32 m0, s49, 65536
    s_mov_b32 s47, 173824
    buffer_load_dwordx4 v5, s[12:15], s47 offen lds
    s_add_u32 m0, s49, 72704
    s_mov_b32 s47, 172032
    buffer_load_dwordx4 v5, s[12:15], s47 offen lds
    s_mov_b32 m0, 56320
    s_mov_b32 s47, 128
    buffer_load_dwordx4 v7, s[8:11], s47 offen lds
    s_mov_b32 m0, 57344
    s_mov_b32 s47, 128
    buffer_load_dwordx4 v8, s[8:11], s47 offen lds
    s_barrier
    v_lshrrev_b32 v9, 3, v0
    v_bfe_u32 v153, v0, 4, 2
    v_lshlrev_b32 v153, 1, v153
    v_and_b32 v154, 7, v0
    v_xor_b32 v153, v153, v154
    v_mul_u32_u24 v9, 896, v9
    v_lshl_add_u32 v9, v153, 4, v9
    s_lshl_b32 s48, s45, 7
    s_mul_i32 s71, s3, 7168
    s_add_u32 s48, s48, s71
    s_cmp_ge_u32 s46, 28
    s_cselect_b32 s48, 0x1000000, s48
    v_add_u32 v9, s48, v9
    v_lshrrev_b32 v152, 1, v1
    v_xor_b32 v152, v152, v2
    v_lshlrev_b32 v152, 4, v152
    v_lshl_add_u32 v152, v1, 7, v152
    s_lshl_b32 s47, s41, 11
    v_add_u32 v10, s47, v152
    v_xor_b32 v11, 64, v10
    v_lshlrev_b32 v12, 4, v2
    v_add_u32 v12, 159744, v12
    s_lshl_b32 s47, s40, 7
    s_lshl_b32 s48, s41, 4
    s_add_u32 s47, s47, s48
    s_lshl_b32 s47, s47, 2
    s_add_u32 s47, s47, 5242880
    v_lshl_add_u32 v13, v0, 2, s47
    v_mov_b32 v152, 16777216
    v_cmp_gt_u32 vcc, 16, v0
    s_nop 1
    v_cndmask_b32 v13, v152, v13, vcc
    v_mov_b32 v153, -1
    buffer_store_dword v153, v13, s[16:19], 0 offen sc1
    s_waitcnt vmcnt(10)
    s_barrier
    ds_read_b128 v[20:23], v10
    ds_read_b128 v[24:27], v12 offset:0
    ds_read_b128 v[28:31], v11
    ds_read_b128 v[32:35], v12 offset:64
    s_add_u32 m0, s49, 79872
    s_mov_b32 s47, 256
    buffer_load_dwordx4 v4, s[8:11], s47 offen lds
    s_add_u32 m0, s49, 83968
    s_mov_b32 s47, 28928
    buffer_load_dwordx4 v4, s[8:11], s47 offen lds
    s_add_u32 m0, s49, 88064
    s_mov_b32 s47, 57600
    buffer_load_dwordx4 v4, s[8:11], s47 offen lds
    s_add_u32 m0, s49, 92160
    s_mov_b32 s47, 86272
    buffer_load_dwordx4 v4, s[8:11], s47 offen lds
    s_add_u32 m0, s49, 98304
    s_mov_b32 s47, 344960
    buffer_load_dwordx4 v5, s[12:15], s47 offen lds
    s_add_u32 m0, s49, 105472
    s_mov_b32 s47, 345856
    buffer_load_dwordx4 v5, s[12:15], s47 offen lds
    s_add_u32 m0, s49, 112640
    s_mov_b32 s47, 344064
    buffer_load_dwordx4 v5, s[12:15], s47 offen lds
    s_mov_b32 m0, 96256
    s_mov_b32 s47, 256
    buffer_load_dwordx4 v7, s[8:11], s47 offen lds
    s_mov_b32 m0, 97280
    s_mov_b32 s47, 256
    buffer_load_dwordx4 v8, s[8:11], s47 offen lds
    s_waitcnt lgkmcnt(2)
    v_mfma_f32_16x16x32_bf16 v[16:19], v[24:27], v[20:23], 0
    s_waitcnt lgkmcnt(0)
    v_mfma_f32_16x16x32_bf16 v[16:19], v[32:35], v[28:31], v[16:19]
    s_waitcnt vmcnt(10)
    s_barrier
    v_add_u32 v10, 0x9c00, v10
    v_add_u32 v11, 0x9c00, v11
    ds_read_b128 v[20:23], v10
    ds_read_b128 v[24:27], v12 offset:128
    ds_read_b128 v[28:31], v11
    ds_read_b128 v[32:35], v12 offset:192
    s_add_u32 m0, s49, 119808
    s_mov_b32 s47, 384
    buffer_load_dwordx4 v4, s[8:11], s47 offen lds
    s_add_u32 m0, s49, 123904
    s_mov_b32 s47, 29056
    buffer_load_dwordx4 v4, s[8:11], s47 offen lds
    s_add_u32 m0, s49, 128000
    s_mov_b32 s47, 57728
    buffer_load_dwordx4 v4, s[8:11], s47 offen lds
    s_add_u32 m0, s49, 132096
    s_mov_b32 s47, 86400
    buffer_load_dwordx4 v4, s[8:11], s47 offen lds
    s_add_u32 m0, s49, 138240
    s_mov_b32 s47, 516992
    buffer_load_dwordx4 v5, s[12:15], s47 offen lds
    s_add_u32 m0, s49, 145408
    s_mov_b32 s47, 517888
    buffer_load_dwordx4 v5, s[12:15], s47 offen lds
    s_add_u32 m0, s49, 152576
    s_mov_b32 s47, 516096
    buffer_load_dwordx4 v5, s[12:15], s47 offen lds
    s_mov_b32 m0, 136192
    s_mov_b32 s47, 384
    buffer_load_dwordx4 v7, s[8:11], s47 offen lds
    s_mov_b32 m0, 137216
    s_mov_b32 s47, 384
    buffer_load_dwordx4 v8, s[8:11], s47 offen lds
    s_waitcnt lgkmcnt(2)
    v_mfma_f32_16x16x32_bf16 v[16:19], v[24:27], v[20:23], v[16:19]
    s_waitcnt lgkmcnt(0)
    v_mfma_f32_16x16x32_bf16 v[16:19], v[32:35], v[28:31], v[16:19]
    s_waitcnt vmcnt(9)
    s_barrier
    v_add_u32 v10, 0x9c00, v10
    v_add_u32 v11, 0x9c00, v11
    ds_read_b128 v[20:23], v10
    ds_read_b128 v[24:27], v12 offset:256
    ds_read_b128 v[28:31], v11
    ds_read_b128 v[32:35], v12 offset:320
    s_add_u32 m0, s49, 0
    s_mov_b32 s47, 512
    buffer_load_dwordx4 v4, s[8:11], s47 offen lds
    s_add_u32 m0, s49, 4096
    s_mov_b32 s47, 29184
    buffer_load_dwordx4 v4, s[8:11], s47 offen lds
    s_add_u32 m0, s49, 8192
    s_mov_b32 s47, 57856
    buffer_load_dwordx4 v4, s[8:11], s47 offen lds
    s_add_u32 m0, s49, 12288
    s_mov_b32 s47, 86528
    buffer_load_dwordx4 v4, s[8:11], s47 offen lds
    s_add_u32 m0, s49, 18432
    s_mov_b32 s47, 689024
    buffer_load_dwordx4 v5, s[12:15], s47 offen lds
    s_add_u32 m0, s49, 25600
    s_mov_b32 s47, 689920
    buffer_load_dwordx4 v5, s[12:15], s47 offen lds
    s_add_u32 m0, s49, 32768
    s_mov_b32 s47, 688128
    buffer_load_dwordx4 v5, s[12:15], s47 offen lds
    s_mov_b32 m0, 16384
    s_mov_b32 s47, 512
    buffer_load_dwordx4 v7, s[8:11], s47 offen lds
    s_mov_b32 m0, 17408
    s_mov_b32 s47, 512
    buffer_load_dwordx4 v8, s[8:11], s47 offen lds
    s_waitcnt lgkmcnt(2)
    v_mfma_f32_16x16x32_bf16 v[16:19], v[24:27], v[20:23], v[16:19]
    s_waitcnt lgkmcnt(0)
    v_mfma_f32_16x16x32_bf16 v[16:19], v[32:35], v[28:31], v[16:19]
    s_waitcnt vmcnt(9)
    s_barrier
    v_add_u32 v10, 0x9c00, v10
    v_add_u32 v11, 0x9c00, v11
    ds_read_b128 v[20:23], v10
    ds_read_b128 v[24:27], v12 offset:384
    ds_read_b128 v[28:31], v11
    ds_read_b128 v[32:35], v12 offset:448
    s_add_u32 m0, s49, 39936
    s_mov_b32 s47, 640
    buffer_load_dwordx4 v4, s[8:11], s47 offen lds
    s_add_u32 m0, s49, 44032
    s_mov_b32 s47, 29312
    buffer_load_dwordx4 v4, s[8:11], s47 offen lds
    s_add_u32 m0, s49, 48128
    s_mov_b32 s47, 57984
    buffer_load_dwordx4 v4, s[8:11], s47 offen lds
    s_add_u32 m0, s49, 52224
    s_mov_b32 s47, 86656
    buffer_load_dwordx4 v4, s[8:11], s47 offen lds
    s_add_u32 m0, s49, 58368
    s_mov_b32 s47, 861056
    buffer_load_dwordx4 v5, s[12:15], s47 offen lds
    s_add_u32 m0, s49, 65536
    s_mov_b32 s47, 861952
    buffer_load_dwordx4 v5, s[12:15], s47 offen lds
    s_add_u32 m0, s49, 72704
    s_mov_b32 s47, 860160
    buffer_load_dwordx4 v5, s[12:15], s47 offen lds
    s_mov_b32 m0, 56320
    s_mov_b32 s47, 640
    buffer_load_dwordx4 v7, s[8:11], s47 offen lds
    s_mov_b32 m0, 57344
    s_mov_b32 s47, 640
    buffer_load_dwordx4 v8, s[8:11], s47 offen lds
    s_waitcnt lgkmcnt(2)
    v_mfma_f32_16x16x32_bf16 v[16:19], v[24:27], v[20:23], v[16:19]
    s_waitcnt lgkmcnt(0)
    v_mfma_f32_16x16x32_bf16 v[16:19], v[32:35], v[28:31], v[16:19]
    s_waitcnt vmcnt(9)
    s_barrier
    v_add_u32 v10, 0xfffe2c00, v10
    v_add_u32 v11, 0xfffe2c00, v11
    ds_read_b128 v[20:23], v10
    ds_read_b128 v[24:27], v12 offset:512
    ds_read_b128 v[28:31], v11
    ds_read_b128 v[32:35], v12 offset:576
    s_add_u32 m0, s49, 79872
    s_mov_b32 s47, 768
    buffer_load_dwordx4 v4, s[8:11], s47 offen lds
    s_add_u32 m0, s49, 83968
    s_mov_b32 s47, 29440
    buffer_load_dwordx4 v4, s[8:11], s47 offen lds
    s_add_u32 m0, s49, 88064
    s_mov_b32 s47, 58112
    buffer_load_dwordx4 v4, s[8:11], s47 offen lds
    s_add_u32 m0, s49, 92160
    s_mov_b32 s47, 86784
    buffer_load_dwordx4 v4, s[8:11], s47 offen lds
    s_add_u32 m0, s49, 98304
    s_mov_b32 s47, 1033088
    buffer_load_dwordx4 v5, s[12:15], s47 offen lds
    s_add_u32 m0, s49, 105472
    s_mov_b32 s47, 1033984
    buffer_load_dwordx4 v5, s[12:15], s47 offen lds
    s_add_u32 m0, s49, 112640
    s_mov_b32 s47, 1032192
    buffer_load_dwordx4 v5, s[12:15], s47 offen lds
    s_mov_b32 m0, 96256
    s_mov_b32 s47, 768
    buffer_load_dwordx4 v7, s[8:11], s47 offen lds
    s_mov_b32 m0, 97280
    s_mov_b32 s47, 768
    buffer_load_dwordx4 v8, s[8:11], s47 offen lds
    s_waitcnt lgkmcnt(2)
    v_mfma_f32_16x16x32_bf16 v[16:19], v[24:27], v[20:23], v[16:19]
    s_waitcnt lgkmcnt(0)
    v_mfma_f32_16x16x32_bf16 v[16:19], v[32:35], v[28:31], v[16:19]
    s_waitcnt vmcnt(9)
    s_barrier
    v_add_u32 v10, 0x9c00, v10
    v_add_u32 v11, 0x9c00, v11
    ds_read_b128 v[20:23], v10
    ds_read_b128 v[24:27], v12 offset:640
    ds_read_b128 v[28:31], v11
    ds_read_b128 v[32:35], v12 offset:704
    s_waitcnt lgkmcnt(2)
    v_mfma_f32_16x16x32_bf16 v[16:19], v[24:27], v[20:23], v[16:19]
    s_waitcnt lgkmcnt(0)
    v_mfma_f32_16x16x32_bf16 v[16:19], v[32:35], v[28:31], v[16:19]
    s_waitcnt vmcnt(0)
    s_barrier
    v_add_u32 v10, 0x9c00, v10
    v_add_u32 v11, 0x9c00, v11
    ds_read_b128 v[20:23], v10
    ds_read_b128 v[24:27], v12 offset:768
    ds_read_b128 v[28:31], v11
    ds_read_b128 v[32:35], v12 offset:832
    s_waitcnt lgkmcnt(2)
    v_mfma_f32_16x16x32_bf16 v[16:19], v[24:27], v[20:23], v[16:19]
    s_waitcnt lgkmcnt(0)
    v_mfma_f32_16x16x32_bf16 v[16:19], v[32:35], v[28:31], v[16:19]
    s_nop 7
    v_cvt_pk_bf16_f32 v17, v16, v16
    v_lshlrev_b32 v16, 16, v17
    v_mul_f32 v16, s68, v16
    v_exp_f32 v16, -v16
    s_nop 0
    v_add_f32 v16, 1.0, v16
    v_rcp_f32 v16, v16
    s_nop 0
    v_cvt_pk_bf16_f32 v17, v16, v16
    v_lshlrev_b32 v16, 16, v17
    buffer_store_dword v16, v13, s[16:19], 0 offen sc1
    s_barrier
    s_barrier
    s_barrier
    s_add_u32 m0, s49, 58368
    s_mov_b32 s47, 0
    buffer_load_dwordx4 v9, s[28:31], s47 offen lds
    s_add_u32 m0, s49, 62464
    s_mov_b32 s47, 28672
    buffer_load_dwordx4 v9, s[28:31], s47 offen lds
    s_add_u32 m0, s49, 66560
    s_mov_b32 s47, 57344
    buffer_load_dwordx4 v9, s[28:31], s47 offen lds
    s_add_u32 m0, s49, 70656
    s_mov_b32 s47, 86016
    buffer_load_dwordx4 v9, s[28:31], s47 offen lds
    s_add_u32 m0, s49, 74752
    s_mov_b32 s47, 114688
    buffer_load_dwordx4 v9, s[28:31], s47 offen lds
    s_add_u32 m0, s49, 78848
    s_mov_b32 s47, 143360
    buffer_load_dwordx4 v9, s[28:31], s47 offen lds
    s_add_u32 m0, s49, 82944
    s_mov_b32 s47, 172032
    buffer_load_dwordx4 v9, s[28:31], s47 offen lds
    s_add_u32 m0, s49, 87040
    s_mov_b32 s47, 200704
    buffer_load_dwordx4 v9, s[28:31], s47 offen lds
    s_add_u32 m0, s49, 91136
    s_mov_b32 s47, 229376
    buffer_load_dwordx4 v9, s[28:31], s47 offen lds
    s_add_u32 m0, s49, 95232
    s_mov_b32 s47, 258048
    buffer_load_dwordx4 v9, s[28:31], s47 offen lds
    s_add_u32 m0, s49, 99328
    s_mov_b32 s47, 286720
    buffer_load_dwordx4 v9, s[28:31], s47 offen lds
    s_add_u32 m0, s49, 103424
    s_mov_b32 s47, 315392
    buffer_load_dwordx4 v9, s[28:31], s47 offen lds
    s_add_u32 m0, s49, 107520
    s_mov_b32 s47, 344064
    buffer_load_dwordx4 v9, s[28:31], s47 offen lds
    s_add_u32 m0, s49, 111616
    s_mov_b32 s47, 372736
    buffer_load_dwordx4 v9, s[28:31], s47 offen lds
    s_mov_b32 m0, 115712
    s_mov_b32 s47, 401408
    buffer_load_dwordx4 v9, s[28:31], s47 offen lds
    s_add_u32 m0, s49, 0
    s_mov_b32 s47, 0
    buffer_load_dwordx4 v9, s[32:35], s47 offen lds
    s_add_u32 m0, s49, 4096
    s_mov_b32 s47, 28672
    buffer_load_dwordx4 v9, s[32:35], s47 offen lds
    s_add_u32 m0, s49, 8192
    s_mov_b32 s47, 57344
    buffer_load_dwordx4 v9, s[32:35], s47 offen lds
    s_add_u32 m0, s49, 12288
    s_mov_b32 s47, 86016
    buffer_load_dwordx4 v9, s[32:35], s47 offen lds
    s_add_u32 m0, s49, 16384
    s_mov_b32 s47, 114688
    buffer_load_dwordx4 v9, s[32:35], s47 offen lds
    s_add_u32 m0, s49, 20480
    s_mov_b32 s47, 143360
    buffer_load_dwordx4 v9, s[32:35], s47 offen lds
    s_add_u32 m0, s49, 24576
    s_mov_b32 s47, 172032
    buffer_load_dwordx4 v9, s[32:35], s47 offen lds
    s_add_u32 m0, s49, 28672
    s_mov_b32 s47, 200704
    buffer_load_dwordx4 v9, s[32:35], s47 offen lds
    s_add_u32 m0, s49, 32768
    s_mov_b32 s47, 229376
    buffer_load_dwordx4 v9, s[32:35], s47 offen lds
    s_add_u32 m0, s49, 36864
    s_mov_b32 s47, 258048
    buffer_load_dwordx4 v9, s[32:35], s47 offen lds
    s_add_u32 m0, s49, 40960
    s_mov_b32 s47, 286720
    buffer_load_dwordx4 v9, s[32:35], s47 offen lds
    s_add_u32 m0, s49, 45056
    s_mov_b32 s47, 315392
    buffer_load_dwordx4 v9, s[32:35], s47 offen lds
    s_add_u32 m0, s49, 49152
    s_mov_b32 s47, 344064
    buffer_load_dwordx4 v9, s[32:35], s47 offen lds
    s_add_u32 m0, s49, 53248
    s_mov_b32 s47, 372736
    buffer_load_dwordx4 v9, s[32:35], s47 offen lds
    s_mov_b32 m0, 57344
    s_mov_b32 s47, 401408
    buffer_load_dwordx4 v9, s[32:35], s47 offen lds
    v_and_b32 v152, 31, v0
    v_lshlrev_b32 v152, 2, v152
    s_mov_b32 s70, 0
    s_mov_b32 s48, 0x01010101
L_fl_5:
    buffer_load_dword v153, v152, s[20:23], 0 offen offset:128 sc1
    s_waitcnt vmcnt(0)
    v_cmp_ne_u32 vcc, s48, v153
    s_nop 0
    s_cbranch_vccz L_fld_6
    s_add_u32 s70, s70, 1
    s_cmp_lt_u32 s70, 30000
    s_cbranch_scc0 L_fld_6
    s_sleep 40
    s_branch L_fl_5
L_fld_6:
    s_cmp_ge_u32 s46, 28
    s_cbranch_scc1 L_end
    s_barrier
    s_waitcnt vmcnt(0)
    s_barrier
    s_branch L_end
L_A_main:
    s_waitcnt lgkmcnt(0)
    s_mov_b32 s8, s72
    s_and_b32 s9, s73, 0xffff
    s_mov_b32 s10, 1835008
    s_mov_b32 s11, 0x20000
    s_cmp_eq_u32 s42, 0
    s_cselect_b32 s47, s74, s80
    s_cselect_b32 s48, s75, s81
    s_mov_b32 s12, s47
    s_and_b32 s13, s48, 0xffff
    s_mov_b32 s14, 1204224
    s_mov_b32 s15, 0x20000
    s_mov_b32 s71, 25088
    s_cmp_eq_u32 s42, 0
    s_cselect_b32 s47, s86, s82
    s_cselect_b32 s48, s87, s83
    s_cselect_b32 s71, 896, s71
    s_mov_b32 s24, s47
    s_and_b32 s25, s48, 0xffff
    s_mov_b32 s26, s71
    s_mov_b32 s27, 0x20000
    s_mov_b32 s16, s92
    s_and_b32 s17, s93, 0xffff
    s_mov_b32 s18, 16777216
    s_mov_b32 s19, 0x20000
    s_mov_b32 s28, s76
    s_and_b32 s29, s77, 0xffff
    s_mov_b32 s30, 401408
    s_mov_b32 s31, 0x20000
    s_mov_b32 s32, s84
    s_and_b32 s33, s85, 0xffff
    s_mov_b32 s34, 401408
    s_mov_b32 s35, 0x20000
    s_mov_b32 s36, s88
    s_and_b32 s37, s89, 0xffff
    s_mov_b32 s38, 1835008
    s_mov_b32 s39, 0x20000
    s_mov_b32 s20, s90
    s_and_b32 s21, s91, 0xffff
    s_mov_b32 s22, 256
    s_mov_b32 s23, 0x20000
    v_bfe_u32 v152, v0, 2, 2
    v_and_b32 v153, 3, v0
    v_lshlrev_b32 v154, 3, v2
    v_lshl_add_u32 v154, v152, 1, v154
    v_mul_u32_u24 v154, 112, v154
    v_lshl_add_u32 v6, v153, 3, v154
    s_mul_i32 s47, s4, 56
    v_add_u32 v6, s47, v6
    v_lshrrev_b32 v152, 1, v1
    v_xor_b32 v152, v152, v2
    v_lshlrev_b32 v152, 4, v152
    v_lshl_add_u32 v152, v1, 7, v152
    s_lshl_b32 s47, s3, 12
    v_add_u32 v4, s47, v152
    v_xor_b32 v5, 64, v4
    s_lshl_b32 s47, s40, 3
    s_lshl_b32 s48, s3, 1
    s_add_u32 s47, s47, s48
    s_lshl_b32 s47, s47, 4
    s_lshl_b32 s48, s41, 1
    s_add_u32 s47, s47, s48
    s_add_u32 s47, s47, s4
    s_lshl_b32 s47, s47, 10
    s_lshl_b32 s48, s42, 21
    s_add_u32 s47, s47, s48
    v_add_u32 v8, s47, v3
    s_mov_b32 s5, 16384
    v_mov_b32 v156, -1
    v_mov_b32 v157, -1
    v_mov_b32 v158, -1
    v_mov_b32 v159, -1
    s_lshl_b32 s47, s41, 4
    s_add_u32 s47, s47, s40
    s_lshl_b32 s47, s47, 3
    s_add_u32 s47, s47, s43
    s_lshl_b32 s47, s47, 10
    s_add_u32 s47, s47, 4194304
    v_add_u32 v9, s47, v3
    buffer_store_dwordx4 v[156:159], v9, s[16:19], 0 offen sc1
    s_barrier
    s_cmp_ge_u32 s43, 6
    s_cbranch_scc1 L_pfx_7
    s_cmp_lt_u32 s43, 3
    s_cselect_b32 s47, s74, s80
    s_cselect_b32 s48, s75, s81
    s_cselect_b32 s71, 0, 3
    s_mov_b32 s52, s47
    s_and_b32 s53, s48, 0xffff
    s_mov_b32 s54, 1204224
    s_mov_b32 s55, 0x20000
    s_sub_u32 s71, s43, s71
    s_lshl_b32 s71, s71, 6
    v_add_u32 v152, s71, v0
    v_mul_u32_u24 v153, 5462, v152
    v_lshrrev_b32 v153, 16, v153
    v_mul_u32_u24 v154, 12, v153
    v_sub_u32 v154, v152, v154
    v_lshrrev_b32 v155, 2, v154
    v_and_b32 v154, 3, v154
    s_mul_i32 s71, s46, 14
    v_add_u32 v153, s71, v153
    v_mul_u32_u24 v153, 2688, v153
    v_mul_u32_u24 v155, 896, v155
    v_lshl_add_u32 v154, v154, 7, v155
    s_lshr_b32 s71, s41, 2
    s_mul_i32 s71, s71, 384
    v_add3_u32 v153, v153, v154, s71
    v_mov_b32 v154, 0x1000000
    v_cmp_gt_u32 vcc, 168, v152
    s_nop 1
    v_cndmask_b32 v153, v154, v153, vcc
    buffer_load_dword v15, v153, s[52:55], 0 offen
    s_nop 0
    s_branch L_pfd_8
L_pfx_7:
    s_sub_u32 s71, s43, 6
    s_lshl_b32 s71, s71, 6
    v_add_u32 v152, s71, v0
    s_mul_i32 s71, s46, 112
    s_lshr_b32 s48, s40, 2
    s_mul_i32 s48, s48, 3584
    s_add_u32 s71, s71, s48
    v_add_u32 v153, s71, v152
    v_lshlrev_b32 v153, 7, v153
    v_mov_b32 v154, 0x1000000
    v_cmp_gt_u32 vcc, 112, v152
    s_nop 1
    v_cndmask_b32 v153, v154, v153, vcc
    s_waitcnt vmcnt(0)
    buffer_load_dword v15, v153, s[8:11], 0 offen
L_pfd_8:
    s_mov_b32 s50, 0x50000
    s_mov_b32 s51, 0x5550055
    s_mov_b32 s52, 0xa0000
    s_mov_b32 s53, 0xaaa00aa
    s_mov_b32 s54, 0x150001
    s_mov_b32 s55, 0x15550155
    s_mov_b32 s56, 0x2a0002
    s_mov_b32 s57, 0x2aaa02aa
    s_mov_b32 s58, 0x55505555
    s_mov_b32 s59, 0x50005500
    s_mov_b32 s60, 0xaaa0aaaa
    s_mov_b32 s61, 0xa000aa00
    s_mov_b32 s62, 0x55405554
    s_mov_b32 s63, 0x40005400
    s_mov_b32 s64, 0xaa80aaa8
    s_mov_b32 s65, 0x8000a800
    s_lshl_b32 s47, s43, 11
    s_add_u32 s47, s47, 116736
    v_add_u32 v10, s47, v3
    v_lshl_add_u32 v11, v0, 3, s47
    s_waitcnt vmcnt(1)
    s_barrier
    ds_read_b128 v[80:83], v4 offset:0
    ds_read_b128 v[84:87], v4 offset:2048
    ds_read_b64_tr_b16 v[92:93], v6 offset:18432
    ds_read_b64_tr_b16 v[94:95], v6 offset:18544
    ds_read_b64_tr_b16 v[96:97], v6 offset:18464
    ds_read_b64_tr_b16 v[98:99], v6 offset:18576
    ds_read_b64_tr_b16 v[100:101], v6 offset:25600
    ds_read_b64_tr_b16 v[102:103], v6 offset:25712
    ds_read_b64_tr_b16 v[104:105], v6 offset:25632
    ds_read_b64_tr_b16 v[106:107], v6 offset:25744
    ds_read_b64_tr_b16 v[108:109], v6 offset:32768
    ds_read_b64_tr_b16 v[110:111], v6 offset:32880
    ds_read_b64_tr_b16 v[112:113], v6 offset:32800
    ds_read_b64_tr_b16 v[114:115], v6 offset:32912
    ds_read_b128 v[116:119], v5 offset:0
    s_waitcnt lgkmcnt(11)
    ds_read_b128 v[120:123], v5 offset:2048
    v_mfma_f32_16x16x32_bf16 v[16:19], v[92:95], v[80:83], 0
    ds_read_b64_tr_b16 v[128:129], v6 offset:22016
    ds_read_b64_tr_b16 v[130:131], v6 offset:22128
    v_mfma_f32_16x16x32_bf16 v[24:27], v[92:95], v[84:87], 0
    ds_read_b64_tr_b16 v[132:133], v6 offset:22048
    s_waitcnt lgkmcnt(13)
    v_mfma_f32_16x16x32_bf16 v[20:23], v[96:99], v[80:83], 0
    ds_read_b64_tr_b16 v[134:135], v6 offset:22160
    ds_read_b64_tr_b16 v[136:137], v6 offset:29184
    v_mfma_f32_16x16x32_bf16 v[28:31], v[96:99], v[84:87], 0
    s_waitcnt lgkmcnt(11)
    ds_read_b64_tr_b16 v[138:139], v6 offset:29296
    v_mfma_f32_16x16x32_bf16 v[32:35], v[80:83], v[100:103], 0
    ds_read_b64_tr_b16 v[140:141], v6 offset:29216
    ds_read_b64_tr_b16 v[142:143], v6 offset:29328
    v_mfma_f32_16x16x32_bf16 v[40:43], v[84:87], v[100:103], 0
    ds_read_b64_tr_b16 v[144:145], v6 offset:36352
    v_mfma_f32_16x16x32_bf16 v[36:39], v[80:83], v[104:107], 0
    s_waitcnt lgkmcnt(11)
    ds_read_b64_tr_b16 v[146:147], v6 offset:36464
    ds_read_b64_tr_b16 v[148:149], v6 offset:36384
    v_mfma_f32_16x16x32_bf16 v[44:47], v[84:87], v[104:107], 0
    ds_read_b64_tr_b16 v[150:151], v6 offset:36496
    v_mfma_f32_16x16x32_bf16 v[48:51], v[108:111], v[80:83], 0
    v_mfma_f32_16x16x32_bf16 v[56:59], v[108:111], v[84:87], 0
    v_mfma_f32_16x16x32_bf16 v[52:55], v[112:115], v[80:83], 0
    v_mfma_f32_16x16x32_bf16 v[60:63], v[112:115], v[84:87], 0
    s_waitcnt lgkmcnt(10)
    v_mfma_f32_16x16x32_bf16 v[16:19], v[128:131], v[116:119], v[16:19]
    v_mfma_f32_16x16x32_bf16 v[24:27], v[128:131], v[120:123], v[24:27]
    s_mov_b32 s47, 2097152
    buffer_store_dwordx4 v[156:159], v8, s[16:19], s47 offen sc1
    buffer_store_dwordx4 v[156:159], v8, s[16:19], 0 offen sc1
    s_barrier
    v_add_u32 v4, 0x9c00, v4
    v_add_u32 v5, 0x9c00, v5
    v_add_u32 v6, 0x9c00, v6
    ds_read_b128 v[80:83], v4 offset:0
    ds_read_b128 v[84:87], v4 offset:2048
    s_waitcnt lgkmcnt(10)
    v_mfma_f32_16x16x32_bf16 v[20:23], v[132:135], v[116:119], v[20:23]
    ds_read_b64_tr_b16 v[92:93], v6 offset:18432
    ds_read_b64_tr_b16 v[94:95], v6 offset:18544
    v_mfma_f32_16x16x32_bf16 v[28:31], v[132:135], v[120:123], v[28:31]
    ds_read_b64_tr_b16 v[96:97], v6 offset:18464
    ds_read_b64_tr_b16 v[98:99], v6 offset:18576
    s_waitcnt lgkmcnt(12)
    v_mfma_f32_16x16x32_bf16 v[32:35], v[116:119], v[136:139], v[32:35]
    ds_read_b64_tr_b16 v[100:101], v6 offset:25600
    ds_read_b64_tr_b16 v[102:103], v6 offset:25712
    v_mfma_f32_16x16x32_bf16 v[40:43], v[120:123], v[136:139], v[40:43]
    ds_read_b64_tr_b16 v[104:105], v6 offset:25632
    s_waitcnt lgkmcnt(11)
    ds_read_b64_tr_b16 v[106:107], v6 offset:25744
    v_mfma_f32_16x16x32_bf16 v[36:39], v[116:119], v[140:143], v[36:39]
    ds_read_b64_tr_b16 v[108:109], v6 offset:32768
    ds_read_b64_tr_b16 v[110:111], v6 offset:32880
    v_mfma_f32_16x16x32_bf16 v[44:47], v[120:123], v[140:143], v[44:47]
    ds_read_b64_tr_b16 v[112:113], v6 offset:32800
    s_waitcnt lgkmcnt(11)
    ds_read_b64_tr_b16 v[114:115], v6 offset:32912
    v_mfma_f32_16x16x32_bf16 v[48:51], v[144:147], v[116:119], v[48:51]
    v_mfma_f32_16x16x32_bf16 v[56:59], v[144:147], v[120:123], v[56:59]
    v_mfma_f32_16x16x32_bf16 v[52:55], v[148:151], v[116:119], v[52:55]
    v_mfma_f32_16x16x32_bf16 v[60:63], v[148:151], v[120:123], v[60:63]
    ds_read_b128 v[116:119], v5 offset:0
    ds_read_b128 v[120:123], v5 offset:2048
    s_waitcnt lgkmcnt(12)
    v_mfma_f32_16x16x32_bf16 v[16:19], v[92:95], v[80:83], v[16:19]
    ds_read_b64_tr_b16 v[128:129], v6 offset:22016
    ds_read_b64_tr_b16 v[130:131], v6 offset:22128
    v_mfma_f32_16x16x32_bf16 v[24:27], v[92:95], v[84:87], v[24:27]
    ds_read_b64_tr_b16 v[132:133], v6 offset:22048
    s_waitcnt lgkmcnt(13)
    v_mfma_f32_16x16x32_bf16 v[20:23], v[96:99], v[80:83], v[20:23]
    ds_read_b64_tr_b16 v[134:135], v6 offset:22160
    ds_read_b64_tr_b16 v[136:137], v6 offset:29184
    v_mfma_f32_16x16x32_bf16 v[28:31], v[96:99], v[84:87], v[28:31]
    s_waitcnt lgkmcnt(11)
    ds_read_b64_tr_b16 v[138:139], v6 offset:29296
    v_mfma_f32_16x16x32_bf16 v[32:35], v[80:83], v[100:103], v[32:35]
    ds_read_b64_tr_b16 v[140:141], v6 offset:29216
    ds_read_b64_tr_b16 v[142:143], v6 offset:29328
    v_mfma_f32_16x16x32_bf16 v[40:43], v[84:87], v[100:103], v[40:43]
    ds_read_b64_tr_b16 v[144:145], v6 offset:36352
    v_mfma_f32_16x16x32_bf16 v[36:39], v[80:83], v[104:107], v[36:39]
    s_waitcnt lgkmcnt(11)
    ds_read_b64_tr_b16 v[146:147], v6 offset:36464
    ds_read_b64_tr_b16 v[148:149], v6 offset:36384
    v_mfma_f32_16x16x32_bf16 v[44:47], v[84:87], v[104:107], v[44:47]
    ds_read_b64_tr_b16 v[150:151], v6 offset:36496
    v_mfma_f32_16x16x32_bf16 v[48:51], v[108:111], v[80:83], v[48:51]
    v_mfma_f32_16x16x32_bf16 v[56:59], v[108:111], v[84:87], v[56:59]
    v_mfma_f32_16x16x32_bf16 v[52:55], v[112:115], v[80:83], v[52:55]
    v_mfma_f32_16x16x32_bf16 v[60:63], v[112:115], v[84:87], v[60:63]
    s_waitcnt lgkmcnt(10)
    v_mfma_f32_16x16x32_bf16 v[16:19], v[128:131], v[116:119], v[16:19]
    v_mfma_f32_16x16x32_bf16 v[24:27], v[128:131], v[120:123], v[24:27]
    s_mov_b32 s47, 2113536
    buffer_store_dwordx4 v[156:159], v8, s[16:19], s47 offen sc1
    buffer_store_dwordx4 v[156:159], v8, s[16:19], s5 offen sc1
    s_barrier
    v_add_u32 v4, 0x9c00, v4
    v_add_u32 v5, 0x9c00, v5
    v_add_u32 v6, 0x9c00, v6
    ds_read_b128 v[80:83], v4 offset:0
    ds_read_b128 v[84:87], v4 offset:2048
    s_waitcnt lgkmcnt(10)
    v_mfma_f32_16x16x32_bf16 v[20:23], v[132:135], v[116:119], v[20:23]
    ds_read_b64_tr_b16 v[92:93], v6 offset:18432
    ds_read_b64_tr_b16 v[94:95], v6 offset:18544
    v_mfma_f32_16x16x32_bf16 v[28:31], v[132:135], v[120:123], v[28:31]
    ds_read_b64_tr_b16 v[96:97], v6 offset:18464
    ds_read_b64_tr_b16 v[98:99], v6 offset:18576
    s_waitcnt lgkmcnt(12)
    v_mfma_f32_16x16x32_bf16 v[32:35], v[116:119], v[136:139], v[32:35]
    ds_read_b64_tr_b16 v[100:101], v6 offset:25600
    ds_read_b64_tr_b16 v[102:103], v6 offset:25712
    v_mfma_f32_16x16x32_bf16 v[40:43], v[120:123], v[136:139], v[40:43]
    ds_read_b64_tr_b16 v[104:105], v6 offset:25632
    s_waitcnt lgkmcnt(11)
    ds_read_b64_tr_b16 v[106:107], v6 offset:25744
    v_mfma_f32_16x16x32_bf16 v[36:39], v[116:119], v[140:143], v[36:39]
    ds_read_b64_tr_b16 v[108:109], v6 offset:32768
    ds_read_b64_tr_b16 v[110:111], v6 offset:32880
    v_mfma_f32_16x16x32_bf16 v[44:47], v[120:123], v[140:143], v[44:47]
    ds_read_b64_tr_b16 v[112:113], v6 offset:32800
    s_waitcnt lgkmcnt(11)
    ds_read_b64_tr_b16 v[114:115], v6 offset:32912
    v_mfma_f32_16x16x32_bf16 v[48:51], v[144:147], v[116:119], v[48:51]
    v_mfma_f32_16x16x32_bf16 v[56:59], v[144:147], v[120:123], v[56:59]
    v_mfma_f32_16x16x32_bf16 v[52:55], v[148:151], v[116:119], v[52:55]
    v_mfma_f32_16x16x32_bf16 v[60:63], v[148:151], v[120:123], v[60:63]
    ds_read_b128 v[116:119], v5 offset:0
    ds_read_b128 v[120:123], v5 offset:2048
    s_waitcnt lgkmcnt(12)
    v_mfma_f32_16x16x32_bf16 v[16:19], v[92:95], v[80:83], v[16:19]
    ds_read_b64_tr_b16 v[128:129], v6 offset:22016
    ds_read_b64_tr_b16 v[130:131], v6 offset:22128
    v_mfma_f32_16x16x32_bf16 v[24:27], v[92:95], v[84:87], v[24:27]
    ds_read_b64_tr_b16 v[132:133], v6 offset:22048
    s_waitcnt lgkmcnt(13)
    v_mfma_f32_16x16x32_bf16 v[20:23], v[96:99], v[80:83], v[20:23]
    ds_read_b64_tr_b16 v[134:135], v6 offset:22160
    ds_read_b64_tr_b16 v[136:137], v6 offset:29184
    v_mfma_f32_16x16x32_bf16 v[28:31], v[96:99], v[84:87], v[28:31]
    s_waitcnt lgkmcnt(11)
    ds_read_b64_tr_b16 v[138:139], v6 offset:29296
    v_mfma_f32_16x16x32_bf16 v[32:35], v[80:83], v[100:103], v[32:35]
    ds_read_b64_tr_b16 v[140:141], v6 offset:29216
    ds_read_b64_tr_b16 v[142:143], v6 offset:29328
    v_mfma_f32_16x16x32_bf16 v[40:43], v[84:87], v[100:103], v[40:43]
    ds_read_b64_tr_b16 v[144:145], v6 offset:36352
    v_mfma_f32_16x16x32_bf16 v[36:39], v[80:83], v[104:107], v[36:39]
    s_waitcnt lgkmcnt(11)
    ds_read_b64_tr_b16 v[146:147], v6 offset:36464
    ds_read_b64_tr_b16 v[148:149], v6 offset:36384
    v_mfma_f32_16x16x32_bf16 v[44:47], v[84:87], v[104:107], v[44:47]
    ds_read_b64_tr_b16 v[150:151], v6 offset:36496
    v_mfma_f32_16x16x32_bf16 v[48:51], v[108:111], v[80:83], v[48:51]
    v_mfma_f32_16x16x32_bf16 v[56:59], v[108:111], v[84:87], v[56:59]
    v_mfma_f32_16x16x32_bf16 v[52:55], v[112:115], v[80:83], v[52:55]
    v_mfma_f32_16x16x32_bf16 v[60:63], v[112:115], v[84:87], v[60:63]
    s_waitcnt lgkmcnt(10)
    v_mfma_f32_16x16x32_bf16 v[16:19], v[128:131], v[116:119], v[16:19]
    v_mfma_f32_16x16x32_bf16 v[24:27], v[128:131], v[120:123], v[24:27]
    s_barrier
    v_add_u32 v4, 0x9c00, v4
    v_add_u32 v5, 0x9c00, v5
    v_add_u32 v6, 0x9c00, v6
    ds_read_b128 v[80:83], v4 offset:0
    ds_read_b128 v[84:87], v4 offset:2048
    s_waitcnt lgkmcnt(10)
    v_mfma_f32_16x16x32_bf16 v[20:23], v[132:135], v[116:119], v[20:23]
    ds_read_b64_tr_b16 v[92:93], v6 offset:18432
    ds_read_b64_tr_b16 v[94:95], v6 offset:18544
    v_mfma_f32_16x16x32_bf16 v[28:31], v[132:135], v[120:123], v[28:31]
    ds_read_b64_tr_b16 v[96:97], v6 offset:18464
    ds_read_b64_tr_b16 v[98:99], v6 offset:18576
    s_waitcnt lgkmcnt(12)
    v_mfma_f32_16x16x32_bf16 v[32:35], v[116:119], v[136:139], v[32:35]
    ds_read_b64_tr_b16 v[100:101], v6 offset:25600
    ds_read_b64_tr_b16 v[102:103], v6 offset:25712
    v_mfma_f32_16x16x32_bf16 v[40:43], v[120:123], v[136:139], v[40:43]
    ds_read_b64_tr_b16 v[104:105], v6 offset:25632
    s_waitcnt lgkmcnt(11)
    ds_read_b64_tr_b16 v[106:107], v6 offset:25744
    v_mfma_f32_16x16x32_bf16 v[36:39], v[116:119], v[140:143], v[36:39]
    ds_read_b64_tr_b16 v[108:109], v6 offset:32768
    ds_read_b64_tr_b16 v[110:111], v6 offset:32880
    v_mfma_f32_16x16x32_bf16 v[44:47], v[120:123], v[140:143], v[44:47]
    ds_read_b64_tr_b16 v[112:113], v6 offset:32800
    s_waitcnt lgkmcnt(11)
    ds_read_b64_tr_b16 v[114:115], v6 offset:32912
    v_mfma_f32_16x16x32_bf16 v[48:51], v[144:147], v[116:119], v[48:51]
    v_mfma_f32_16x16x32_bf16 v[56:59], v[144:147], v[120:123], v[56:59]
    v_mfma_f32_16x16x32_bf16 v[52:55], v[148:151], v[116:119], v[52:55]
    v_mfma_f32_16x16x32_bf16 v[60:63], v[148:151], v[120:123], v[60:63]
    ds_read_b128 v[116:119], v5 offset:0
    ds_read_b128 v[120:123], v5 offset:2048
    s_waitcnt lgkmcnt(12)
    v_mfma_f32_16x16x32_bf16 v[16:19], v[92:95], v[80:83], v[16:19]
    ds_read_b64_tr_b16 v[128:129], v6 offset:22016
    ds_read_b64_tr_b16 v[130:131], v6 offset:22128
    v_mfma_f32_16x16x32_bf16 v[24:27], v[92:95], v[84:87], v[24:27]
    ds_read_b64_tr_b16 v[132:133], v6 offset:22048
    s_waitcnt lgkmcnt(13)
    v_mfma_f32_16x16x32_bf16 v[20:23], v[96:99], v[80:83], v[20:23]
    ds_read_b64_tr_b16 v[134:135], v6 offset:22160
    ds_read_b64_tr_b16 v[136:137], v6 offset:29184
    v_mfma_f32_16x16x32_bf16 v[28:31], v[96:99], v[84:87], v[28:31]
    s_waitcnt lgkmcnt(11)
    ds_read_b64_tr_b16 v[138:139], v6 offset:29296
    v_mfma_f32_16x16x32_bf16 v[32:35], v[80:83], v[100:103], v[32:35]
    ds_read_b64_tr_b16 v[140:141], v6 offset:29216
    ds_read_b64_tr_b16 v[142:143], v6 offset:29328
    v_mfma_f32_16x16x32_bf16 v[40:43], v[84:87], v[100:103], v[40:43]
    ds_read_b64_tr_b16 v[144:145], v6 offset:36352
    v_mfma_f32_16x16x32_bf16 v[36:39], v[80:83], v[104:107], v[36:39]
    s_waitcnt lgkmcnt(11)
    ds_read_b64_tr_b16 v[146:147], v6 offset:36464
    ds_read_b64_tr_b16 v[148:149], v6 offset:36384
    v_mfma_f32_16x16x32_bf16 v[44:47], v[84:87], v[104:107], v[44:47]
    ds_read_b64_tr_b16 v[150:151], v6 offset:36496
    v_mfma_f32_16x16x32_bf16 v[48:51], v[108:111], v[80:83], v[48:51]
    v_mfma_f32_16x16x32_bf16 v[56:59], v[108:111], v[84:87], v[56:59]
    v_mfma_f32_16x16x32_bf16 v[52:55], v[112:115], v[80:83], v[52:55]
    v_mfma_f32_16x16x32_bf16 v[60:63], v[112:115], v[84:87], v[60:63]
    s_waitcnt lgkmcnt(10)
    v_mfma_f32_16x16x32_bf16 v[16:19], v[128:131], v[116:119], v[16:19]
    v_mfma_f32_16x16x32_bf16 v[24:27], v[128:131], v[120:123], v[24:27]
    s_barrier
    v_add_u32 v4, 0xfffe2c00, v4
    v_add_u32 v5, 0xfffe2c00, v5
    v_add_u32 v6, 0xfffe2c00, v6
    ds_read_b128 v[80:83], v4 offset:0
    ds_read_b128 v[84:87], v4 offset:2048
    s_waitcnt lgkmcnt(10)
    v_mfma_f32_16x16x32_bf16 v[20:23], v[132:135], v[116:119], v[20:23]
    ds_read_b64_tr_b16 v[92:93], v6 offset:18432
    ds_read_b64_tr_b16 v[94:95], v6 offset:18544
    v_mfma_f32_16x16x32_bf16 v[28:31], v[132:135], v[120:123], v[28:31]
    ds_read_b64_tr_b16 v[96:97], v6 offset:18464
    ds_read_b64_tr_b16 v[98:99], v6 offset:18576
    s_waitcnt lgkmcnt(12)
    v_mfma_f32_16x16x32_bf16 v[32:35], v[116:119], v[136:139], v[32:35]
    ds_read_b64_tr_b16 v[100:101], v6 offset:25600
    ds_read_b64_tr_b16 v[102:103], v6 offset:25712
    v_mfma_f32_16x16x32_bf16 v[40:43], v[120:123], v[136:139], v[40:43]
    ds_read_b64_tr_b16 v[104:105], v6 offset:25632
    s_waitcnt lgkmcnt(11)
    ds_read_b64_tr_b16 v[106:107], v6 offset:25744
    v_mfma_f32_16x16x32_bf16 v[36:39], v[116:119], v[140:143], v[36:39]
    ds_read_b64_tr_b16 v[108:109], v6 offset:32768
    ds_read_b64_tr_b16 v[110:111], v6 offset:32880
    v_mfma_f32_16x16x32_bf16 v[44:47], v[120:123], v[140:143], v[44:47]
    ds_read_b64_tr_b16 v[112:113], v6 offset:32800
    s_waitcnt lgkmcnt(11)
    ds_read_b64_tr_b16 v[114:115], v6 offset:32912
    v_mfma_f32_16x16x32_bf16 v[48:51], v[144:147], v[116:119], v[48:51]
    v_mfma_f32_16x16x32_bf16 v[56:59], v[144:147], v[120:123], v[56:59]
    v_mfma_f32_16x16x32_bf16 v[52:55], v[148:151], v[116:119], v[52:55]
    v_mfma_f32_16x16x32_bf16 v[60:63], v[148:151], v[120:123], v[60:63]
    ds_read_b128 v[116:119], v5 offset:0
    ds_read_b128 v[120:123], v5 offset:2048
    s_waitcnt lgkmcnt(12)
    v_mfma_f32_16x16x32_bf16 v[16:19], v[92:95], v[80:83], v[16:19]
    ds_read_b64_tr_b16 v[128:129], v6 offset:22016
    ds_read_b64_tr_b16 v[130:131], v6 offset:22128
    v_mfma_f32_16x16x32_bf16 v[24:27], v[92:95], v[84:87], v[24:27]
    ds_read_b64_tr_b16 v[132:133], v6 offset:22048
    s_waitcnt lgkmcnt(13)
    v_mfma_f32_16x16x32_bf16 v[20:23], v[96:99], v[80:83], v[20:23]
    ds_read_b64_tr_b16 v[134:135], v6 offset:22160
    ds_read_b64_tr_b16 v[136:137], v6 offset:29184
    v_mfma_f32_16x16x32_bf16 v[28:31], v[96:99], v[84:87], v[28:31]
    s_waitcnt lgkmcnt(11)
    ds_read_b64_tr_b16 v[138:139], v6 offset:29296
    v_mfma_f32_16x16x32_bf16 v[32:35], v[80:83], v[100:103], v[32:35]
    ds_read_b64_tr_b16 v[140:141], v6 offset:29216
    ds_read_b64_tr_b16 v[142:143], v6 offset:29328
    v_mfma_f32_16x16x32_bf16 v[40:43], v[84:87], v[100:103], v[40:43]
    ds_read_b64_tr_b16 v[144:145], v6 offset:36352
    v_mfma_f32_16x16x32_bf16 v[36:39], v[80:83], v[104:107], v[36:39]
    s_waitcnt lgkmcnt(11)
    ds_read_b64_tr_b16 v[146:147], v6 offset:36464
    ds_read_b64_tr_b16 v[148:149], v6 offset:36384
    v_mfma_f32_16x16x32_bf16 v[44:47], v[84:87], v[104:107], v[44:47]
    ds_read_b64_tr_b16 v[150:151], v6 offset:36496
    v_mfma_f32_16x16x32_bf16 v[48:51], v[108:111], v[80:83], v[48:51]
    v_mfma_f32_16x16x32_bf16 v[56:59], v[108:111], v[84:87], v[56:59]
    v_mfma_f32_16x16x32_bf16 v[52:55], v[112:115], v[80:83], v[52:55]
    v_mfma_f32_16x16x32_bf16 v[60:63], v[112:115], v[84:87], v[60:63]
    s_waitcnt lgkmcnt(10)
    v_mfma_f32_16x16x32_bf16 v[16:19], v[128:131], v[116:119], v[16:19]
    v_mfma_f32_16x16x32_bf16 v[24:27], v[128:131], v[120:123], v[24:27]
    s_waitcnt vmcnt(0)
    s_barrier
    v_add_u32 v4, 0x9c00, v4
    v_add_u32 v5, 0x9c00, v5
    v_add_u32 v6, 0x9c00, v6
    ds_read_b128 v[80:83], v4 offset:0
    ds_read_b128 v[84:87], v4 offset:2048
    s_waitcnt lgkmcnt(10)
    v_mfma_f32_16x16x32_bf16 v[20:23], v[132:135], v[116:119], v[20:23]
    ds_read_b64_tr_b16 v[92:93], v6 offset:18432
    ds_read_b64_tr_b16 v[94:95], v6 offset:18544
    v_mfma_f32_16x16x32_bf16 v[28:31], v[132:135], v[120:123], v[28:31]
    ds_read_b64_tr_b16 v[96:97], v6 offset:18464
    ds_read_b64_tr_b16 v[98:99], v6 offset:18576
    s_waitcnt lgkmcnt(12)
    v_mfma_f32_16x16x32_bf16 v[32:35], v[116:119], v[136:139], v[32:35]
    ds_read_b64_tr_b16 v[100:101], v6 offset:25600
    ds_read_b64_tr_b16 v[102:103], v6 offset:25712
    v_mfma_f32_16x16x32_bf16 v[40:43], v[120:123], v[136:139], v[40:43]
    ds_read_b64_tr_b16 v[104:105], v6 offset:25632
    s_waitcnt lgkmcnt(11)
    ds_read_b64_tr_b16 v[106:107], v6 offset:25744
    v_mfma_f32_16x16x32_bf16 v[36:39], v[116:119], v[140:143], v[36:39]
    ds_read_b64_tr_b16 v[108:109], v6 offset:32768
    ds_read_b64_tr_b16 v[110:111], v6 offset:32880
    v_mfma_f32_16x16x32_bf16 v[44:47], v[120:123], v[140:143], v[44:47]
    ds_read_b64_tr_b16 v[112:113], v6 offset:32800
    s_waitcnt lgkmcnt(11)
    ds_read_b64_tr_b16 v[114:115], v6 offset:32912
    v_mfma_f32_16x16x32_bf16 v[48:51], v[144:147], v[116:119], v[48:51]
    v_mfma_f32_16x16x32_bf16 v[56:59], v[144:147], v[120:123], v[56:59]
    v_mfma_f32_16x16x32_bf16 v[52:55], v[148:151], v[116:119], v[52:55]
    v_mfma_f32_16x16x32_bf16 v[60:63], v[148:151], v[120:123], v[60:63]
    ds_read_b128 v[116:119], v5 offset:0
    ds_read_b128 v[120:123], v5 offset:2048
    s_waitcnt lgkmcnt(12)
    v_mfma_f32_16x16x32_bf16 v[16:19], v[92:95], v[80:83], v[16:19]
    ds_read_b64_tr_b16 v[128:129], v6 offset:22016
    ds_read_b64_tr_b16 v[130:131], v6 offset:22128
    v_mfma_f32_16x16x32_bf16 v[24:27], v[92:95], v[84:87], v[24:27]
    ds_read_b64_tr_b16 v[132:133], v6 offset:22048
    s_waitcnt lgkmcnt(13)
    v_mfma_f32_16x16x32_bf16 v[20:23], v[96:99], v[80:83], v[20:23]
    ds_read_b64_tr_b16 v[134:135], v6 offset:22160
    ds_read_b64_tr_b16 v[136:137], v6 offset:29184
    v_mfma_f32_16x16x32_bf16 v[28:31], v[96:99], v[84:87], v[28:31]
    s_waitcnt lgkmcnt(11)
    ds_read_b64_tr_b16 v[138:139], v6 offset:29296
    v_mfma_f32_16x16x32_bf16 v[32:35], v[80:83], v[100:103], v[32:35]
    ds_read_b64_tr_b16 v[140:141], v6 offset:29216
    ds_read_b64_tr_b16 v[142:143], v6 offset:29328
    v_mfma_f32_16x16x32_bf16 v[40:43], v[84:87], v[100:103], v[40:43]
    ds_read_b64_tr_b16 v[144:145], v6 offset:36352
    v_mfma_f32_16x16x32_bf16 v[36:39], v[80:83], v[104:107], v[36:39]
    s_waitcnt lgkmcnt(11)
    ds_read_b64_tr_b16 v[146:147], v6 offset:36464
    ds_read_b64_tr_b16 v[148:149], v6 offset:36384
    v_mfma_f32_16x16x32_bf16 v[44:47], v[84:87], v[104:107], v[44:47]
    ds_read_b64_tr_b16 v[150:151], v6 offset:36496
    v_mfma_f32_16x16x32_bf16 v[48:51], v[108:111], v[80:83], v[48:51]
    v_mfma_f32_16x16x32_bf16 v[56:59], v[108:111], v[84:87], v[56:59]
    v_mfma_f32_16x16x32_bf16 v[52:55], v[112:115], v[80:83], v[52:55]
    v_mfma_f32_16x16x32_bf16 v[60:63], v[112:115], v[84:87], v[60:63]
    s_waitcnt lgkmcnt(10)
    v_mfma_f32_16x16x32_bf16 v[16:19], v[128:131], v[116:119], v[16:19]
    v_mfma_f32_16x16x32_bf16 v[24:27], v[128:131], v[120:123], v[24:27]
    s_barrier
    v_add_u32 v4, 0x9c00, v4
    v_add_u32 v5, 0x9c00, v5
    v_add_u32 v6, 0x9c00, v6
    ds_read_b128 v[80:83], v4 offset:0
    ds_read_b128 v[84:87], v4 offset:2048
    s_waitcnt lgkmcnt(10)
    v_mfma_f32_16x16x32_bf16 v[20:23], v[132:135], v[116:119], v[20:23]
    ds_read_b64_tr_b16 v[92:93], v6 offset:18432
    ds_read_b64_tr_b16 v[94:95], v6 offset:18544
    v_mfma_f32_16x16x32_bf16 v[28:31], v[132:135], v[120:123], v[28:31]
    ds_read_b64_tr_b16 v[96:97], v6 offset:18464
    ds_read_b64_tr_b16 v[98:99], v6 offset:18576
    s_waitcnt lgkmcnt(12)
    v_mfma_f32_16x16x32_bf16 v[32:35], v[116:119], v[136:139], v[32:35]
    ds_read_b64_tr_b16 v[100:101], v6 offset:25600
    ds_read_b64_tr_b16 v[102:103], v6 offset:25712
    v_mfma_f32_16x16x32_bf16 v[40:43], v[120:123], v[136:139], v[40:43]
    ds_read_b64_tr_b16 v[104:105], v6 offset:25632
    s_waitcnt lgkmcnt(11)
    ds_read_b64_tr_b16 v[106:107], v6 offset:25744
    v_mfma_f32_16x16x32_bf16 v[36:39], v[116:119], v[140:143], v[36:39]
    ds_read_b64_tr_b16 v[108:109], v6 offset:32768
    ds_read_b64_tr_b16 v[110:111], v6 offset:32880
    v_mfma_f32_16x16x32_bf16 v[44:47], v[120:123], v[140:143], v[44:47]
    ds_read_b64_tr_b16 v[112:113], v6 offset:32800
    s_waitcnt lgkmcnt(11)
    ds_read_b64_tr_b16 v[114:115], v6 offset:32912
    v_mfma_f32_16x16x32_bf16 v[48:51], v[144:147], v[116:119], v[48:51]
    v_mfma_f32_16x16x32_bf16 v[56:59], v[144:147], v[120:123], v[56:59]
    v_mfma_f32_16x16x32_bf16 v[52:55], v[148:151], v[116:119], v[52:55]
    v_mfma_f32_16x16x32_bf16 v[60:63], v[148:151], v[120:123], v[60:63]
    ds_read_b128 v[116:119], v5 offset:0
    ds_read_b128 v[120:123], v5 offset:2048
    s_waitcnt lgkmcnt(12)
    v_mfma_f32_16x16x32_bf16 v[16:19], v[92:95], v[80:83], v[16:19]
    ds_read_b64_tr_b16 v[128:129], v6 offset:22016
    ds_read_b64_tr_b16 v[130:131], v6 offset:22128
    v_mfma_f32_16x16x32_bf16 v[24:27], v[92:95], v[84:87], v[24:27]
    ds_read_b64_tr_b16 v[132:133], v6 offset:22048
    s_waitcnt lgkmcnt(13)
    v_mfma_f32_16x16x32_bf16 v[20:23], v[96:99], v[80:83], v[20:23]
    ds_read_b64_tr_b16 v[134:135], v6 offset:22160
    ds_read_b64_tr_b16 v[136:137], v6 offset:29184
    v_mfma_f32_16x16x32_bf16 v[28:31], v[96:99], v[84:87], v[28:31]
    s_waitcnt lgkmcnt(11)
    ds_read_b64_tr_b16 v[138:139], v6 offset:29296
    v_mfma_f32_16x16x32_bf16 v[32:35], v[80:83], v[100:103], v[32:35]
    ds_read_b64_tr_b16 v[140:141], v6 offset:29216
    ds_read_b64_tr_b16 v[142:143], v6 offset:29328
    v_mfma_f32_16x16x32_bf16 v[40:43], v[84:87], v[100:103], v[40:43]
    ds_read_b64_tr_b16 v[144:145], v6 offset:36352
    v_mfma_f32_16x16x32_bf16 v[36:39], v[80:83], v[104:107], v[36:39]
    s_waitcnt lgkmcnt(11)
    ds_read_b64_tr_b16 v[146:147], v6 offset:36464
    ds_read_b64_tr_b16 v[148:149], v6 offset:36384
    v_mfma_f32_16x16x32_bf16 v[44:47], v[84:87], v[104:107], v[44:47]
    ds_read_b64_tr_b16 v[150:151], v6 offset:36496
    v_mfma_f32_16x16x32_bf16 v[48:51], v[108:111], v[80:83], v[48:51]
    v_mfma_f32_16x16x32_bf16 v[56:59], v[108:111], v[84:87], v[56:59]
    v_mfma_f32_16x16x32_bf16 v[52:55], v[112:115], v[80:83], v[52:55]
    v_mfma_f32_16x16x32_bf16 v[60:63], v[112:115], v[84:87], v[60:63]
    s_waitcnt lgkmcnt(10)
    v_mfma_f32_16x16x32_bf16 v[16:19], v[128:131], v[116:119], v[16:19]
    v_mfma_f32_16x16x32_bf16 v[24:27], v[128:131], v[120:123], v[24:27]
    s_waitcnt lgkmcnt(8)
    v_mfma_f32_16x16x32_bf16 v[20:23], v[132:135], v[116:119], v[20:23]
    v_mfma_f32_16x16x32_bf16 v[28:31], v[132:135], v[120:123], v[28:31]
    s_waitcnt lgkmcnt(6)
    v_mfma_f32_16x16x32_bf16 v[32:35], v[116:119], v[136:139], v[32:35]
    v_mfma_f32_16x16x32_bf16 v[40:43], v[120:123], v[136:139], v[40:43]
    s_waitcnt lgkmcnt(4)
    v_mfma_f32_16x16x32_bf16 v[36:39], v[116:119], v[140:143], v[36:39]
    v_mfma_f32_16x16x32_bf16 v[44:47], v[120:123], v[140:143], v[44:47]
    s_waitcnt lgkmcnt(2)
    v_mfma_f32_16x16x32_bf16 v[48:51], v[144:147], v[116:119], v[48:51]
    v_mfma_f32_16x16x32_bf16 v[56:59], v[144:147], v[120:123], v[56:59]
    s_waitcnt lgkmcnt(0)
    v_mfma_f32_16x16x32_bf16 v[52:55], v[148:151], v[116:119], v[52:55]
    v_mfma_f32_16x16x32_bf16 v[60:63], v[148:151], v[120:123], v[60:63]
    v_cvt_pk_bf16_f32 v84, v16, v17
    v_cvt_pk_bf16_f32 v85, v18, v19
    v_cvt_pk_bf16_f32 v86, v20, v21
    v_cvt_pk_bf16_f32 v87, v22, v23
    v_cndmask_b32 v86, v86, 0, s[66:67]
    v_cndmask_b32 v87, v87, 0, s[66:67]
    v_cvt_pk_bf16_f32 v94, v32, v33
    v_cvt_pk_bf16_f32 v95, v34, v35
    v_mov_b32 v100, v94
    v_mov_b32 v101, v95
    v_cvt_pk_bf16_f32 v98, v36, v37
    v_cvt_pk_bf16_f32 v99, v38, v39
    v_mov_b32 v104, v98
    v_mov_b32 v105, v99
    v_cvt_pk_bf16_f32 v88, v24, v25
    v_cvt_pk_bf16_f32 v89, v26, v27
    v_cvt_pk_bf16_f32 v90, v28, v29
    v_cvt_pk_bf16_f32 v91, v30, v31
    v_cndmask_b32 v90, v90, 0, s[66:67]
    v_cndmask_b32 v91, v91, 0, s[66:67]
    v_cvt_pk_bf16_f32 v102, v40, v41
    v_cvt_pk_bf16_f32 v103, v42, v43
    v_cvt_pk_bf16_f32 v106, v44, v45
    v_cvt_pk_bf16_f32 v107, v46, v47
    s_barrier
    ds_write_b128 v10, v[88:91] offset:4096
    ds_write_b64 v11, v[102:103] offset:5120
    ds_write_b64 v11, v[106:107] offset:5632
    v_mov_b32 v160, 0xf149f2ca
    v_cvt_pk_bf16_f32 v108, v48, v49
    v_cvt_pk_bf16_f32 v109, v50, v51
    v_cvt_pk_bf16_f32 v110, v52, v53
    v_cvt_pk_bf16_f32 v111, v54, v55
    v_cndmask_b32 v110, v110, 0, s[66:67]
    v_cndmask_b32 v111, v111, 0, s[66:67]
    v_cvt_pk_bf16_f32 v128, v56, v57
    v_cvt_pk_bf16_f32 v129, v58, v59
    v_cvt_pk_bf16_f32 v130, v60, v61
    v_cvt_pk_bf16_f32 v131, v62, v63
    v_cndmask_b32 v130, v130, 0, s[66:67]
    v_cndmask_b32 v131, v131, 0, s[66:67]
    s_waitcnt lgkmcnt(0)
    s_barrier
    ds_read_b128 v[80:83], v10
    ds_read_b64 v[92:93], v11 offset:1024
    ds_read_b64 v[96:97], v11 offset:1536
    v_mfma_f32_16x16x32_bf16 v[136:139], v[88:91], v[128:131], 0
    v_mfma_f32_16x16x32_bf16 v[116:119], v[84:87], v[108:111], 0
    v_mfma_f32_16x16x32_bf16 v[132:135], v[84:87], v[128:131], 0
    s_waitcnt lgkmcnt(2)
    v_mfma_f32_16x16x32_bf16 v[112:115], v[80:83], v[108:111], 0
    s_nop 5
    v_cvt_pk_bf16_f32 v140, v132, v133
    s_nop 0
    v_cvt_pk_bf16_f32 v120, v112, v113
    v_cvt_pk_bf16_f32 v141, v134, v135
    v_cvt_pk_bf16_f32 v121, v114, v115
    v_cvt_pk_bf16_f32 v142, v136, v137
    v_cvt_pk_bf16_f32 v122, v116, v117
    v_cvt_pk_bf16_f32 v143, v138, v139
    v_cvt_pk_bf16_f32 v123, v118, v119
    v_lshlrev_b32 v132, 16, v140
    v_lshlrev_b32 v112, 16, v120
    v_and_b32 v133, s67, v140
    v_and_b32 v113, s67, v120
    v_lshlrev_b32 v134, 16, v141
    v_lshlrev_b32 v114, 16, v121
    v_and_b32 v135, s67, v141
    v_and_b32 v115, s67, v121
    v_lshlrev_b32 v136, 16, v142
    v_lshlrev_b32 v116, 16, v122
    v_and_b32 v137, s67, v142
    v_and_b32 v117, s67, v122
    v_lshlrev_b32 v138, 16, v143
    v_lshlrev_b32 v118, 16, v123
    v_and_b32 v139, s67, v143
    v_and_b32 v119, s67, v123
    v_mul_f32 v132, s69, v132
    v_mul_f32 v112, s69, v112
    v_mul_f32 v133, s69, v133
    v_mul_f32 v113, s69, v113
    v_mul_f32 v134, s69, v134
    v_mul_f32 v114, s69, v114
    v_mul_f32 v135, s69, v135
    v_mul_f32 v115, s69, v115
    v_mul_f32 v136, s69, v136
    v_mul_f32 v116, s69, v116
    v_mul_f32 v137, s69, v137
    v_mul_f32 v117, s69, v117
    v_mul_f32 v138, s69, v138
    v_mul_f32 v118, s69, v118
    v_mul_f32 v139, s69, v139
    v_mul_f32 v119, s69, v119
    v_cvt_pk_bf16_f32 v140, v132, v133
    v_cvt_pk_bf16_f32 v120, v112, v113
    v_cvt_pk_bf16_f32 v141, v134, v135
    v_cvt_pk_bf16_f32 v121, v114, v115
    v_cvt_pk_bf16_f32 v142, v136, v137
    v_cvt_pk_bf16_f32 v122, v116, v117
    v_cvt_pk_bf16_f32 v143, v138, v139
    v_cvt_pk_bf16_f32 v123, v118, v119
    v_lshlrev_b32 v132, 16, v140
    v_lshlrev_b32 v112, 16, v120
    v_and_b32 v133, s67, v140
    v_and_b32 v113, s67, v120
    v_lshlrev_b32 v134, 16, v141
    v_lshlrev_b32 v114, 16, v121
    v_and_b32 v135, s67, v141
    v_and_b32 v115, s67, v121
    v_lshlrev_b32 v136, 16, v142
    v_lshlrev_b32 v116, 16, v122
    v_and_b32 v137, s67, v142
    v_and_b32 v117, s67, v122
    v_lshlrev_b32 v138, 16, v143
    v_lshlrev_b32 v118, 16, v123
    v_and_b32 v139, s67, v143
    v_and_b32 v119, s67, v123
    v_cndmask_b32 v132, v160, v132, s[50:51]
    v_cndmask_b32 v112, v160, v112, s[50:51]
    v_cndmask_b32 v133, v160, v133, s[52:53]
    v_cndmask_b32 v113, v160, v113, s[52:53]
    v_cndmask_b32 v134, v160, v134, s[54:55]
    v_cndmask_b32 v114, v160, v114, s[54:55]
    v_cndmask_b32 v135, v160, v135, s[56:57]
    v_cndmask_b32 v115, v160, v115, s[56:57]
    v_cndmask_b32 v136, v160, v136, s[58:59]
    v_cndmask_b32 v116, v160, v116, s[58:59]
    v_cndmask_b32 v137, v160, v137, s[60:61]
    v_cndmask_b32 v117, v160, v117, s[60:61]
    v_cndmask_b32 v138, v160, v138, s[62:63]
    v_cndmask_b32 v118, v160, v118, s[62:63]
    v_cndmask_b32 v139, v160, v139, s[64:65]
    v_cndmask_b32 v119, v160, v119, s[64:65]
    v_max3_f32 v153, v132, v133, v134
    v_max3_f32 v152, v112, v113, v114
    v_max3_f32 v153, v153, v135, v136
    v_max3_f32 v152, v152, v115, v116
    v_max3_f32 v153, v153, v137, v138
    v_max3_f32 v152, v152, v117, v118
    v_max_f32 v153, v153, v139
    v_max_f32 v152, v152, v119
    s_nop 1
    v_permlane32_swap_b32 v152, v153
    v_max_f32 v152, v152, v153
    v_mov_b32 v156, v152
    s_nop 1
    v_permlane16_swap_b32 v152, v156
    v_max_f32 v152, v152, v156
    v_mov_b32 v153, v152
    s_nop 1
    v_permlane32_swap_b32 v152, v153
    v_mul_f32 v152, s68, v152
    v_mul_f32 v153, s68, v153
    v_fma_f32 v112, v112, s68, -v152
    v_fma_f32 v132, v132, s68, -v153
    v_fma_f32 v113, v113, s68, -v152
    v_fma_f32 v133, v133, s68, -v153
    v_fma_f32 v114, v114, s68, -v152
    v_fma_f32 v134, v134, s68, -v153
    v_fma_f32 v115, v115, s68, -v152
    v_fma_f32 v135, v135, s68, -v153
    v_fma_f32 v116, v116, s68, -v152
    v_fma_f32 v136, v136, s68, -v153
    v_fma_f32 v117, v117, s68, -v152
    v_fma_f32 v137, v137, s68, -v153
    v_fma_f32 v118, v118, s68, -v152
    v_fma_f32 v138, v138, s68, -v153
    v_fma_f32 v119, v119, s68, -v152
    v_fma_f32 v139, v139, s68, -v153
    v_exp_f32 v112, v112
    v_exp_f32 v132, v132
    v_exp_f32 v113, v113
    v_exp_f32 v133, v133
    v_exp_f32 v114, v114
    v_exp_f32 v134, v134
    v_exp_f32 v115, v115
    v_exp_f32 v135, v135
    v_exp_f32 v116, v116
    v_exp_f32 v136, v136
    v_exp_f32 v117, v117
    v_exp_f32 v137, v137
    v_exp_f32 v118, v118
    v_exp_f32 v138, v138
    v_exp_f32 v119, v119
    v_exp_f32 v139, v139
    v_add_f32 v154, v112, v113
    v_add_f32 v155, v132, v133
    v_add_f32 v154, v154, v114
    v_add_f32 v155, v155, v134
    v_add_f32 v154, v154, v115
    v_add_f32 v155, v155, v135
    v_add_f32 v154, v154, v116
    v_add_f32 v155, v155, v136
    v_add_f32 v154, v154, v117
    v_add_f32 v155, v155, v137
    v_add_f32 v154, v154, v118
    v_add_f32 v155, v155, v138
    v_add_f32 v154, v154, v119
    v_add_f32 v155, v155, v139
    s_nop 1
    v_permlane32_swap_b32 v154, v155
    v_add_f32 v154, v154, v155
    v_mov_b32 v156, v154
    s_nop 1
    v_permlane16_swap_b32 v154, v156
    v_add_f32 v154, v154, v156
    v_mov_b32 v155, v154
    s_nop 1
    v_permlane32_swap_b32 v154, v155
    v_rcp_f32 v154, v154
    v_rcp_f32 v155, v155
    v_mul_f32 v112, v112, v154
    v_mul_f32 v132, v132, v155
    v_mul_f32 v113, v113, v154
    v_mul_f32 v133, v133, v155
    v_mul_f32 v114, v114, v154
    v_mul_f32 v134, v134, v155
    v_mul_f32 v115, v115, v154
    v_mul_f32 v135, v135, v155
    v_mul_f32 v116, v116, v154
    v_mul_f32 v136, v136, v155
    v_mul_f32 v117, v117, v154
    v_mul_f32 v137, v137, v155
    v_mul_f32 v118, v118, v154
    v_mul_f32 v138, v138, v155
    v_mul_f32 v119, v119, v154
    v_mul_f32 v139, v139, v155
    v_cvt_pk_bf16_f32 v124, v112, v113
    v_cvt_pk_bf16_f32 v144, v132, v133
    v_cvt_pk_bf16_f32 v125, v114, v115
    v_cvt_pk_bf16_f32 v145, v134, v135
    v_cvt_pk_bf16_f32 v126, v116, v117
    v_cvt_pk_bf16_f32 v146, v136, v137
    v_cvt_pk_bf16_f32 v127, v118, v119
    v_cvt_pk_bf16_f32 v147, v138, v139
    s_waitcnt lgkmcnt(1)
    v_mfma_f32_16x16x32_bf16 v[32:35], v[92:95], v[124:127], 0
    v_mfma_f32_16x16x32_bf16 v[40:43], v[100:103], v[144:147], 0
    s_waitcnt lgkmcnt(0)
    v_mfma_f32_16x16x32_bf16 v[36:39], v[96:99], v[124:127], 0
    v_mfma_f32_16x16x32_bf16 v[44:47], v[104:107], v[144:147], 0
    s_nop 3
    v_cvt_pk_bf16_f32 v108, v32, v33
    v_cvt_pk_bf16_f32 v128, v40, v41
    v_cvt_pk_bf16_f32 v109, v34, v35
    v_cvt_pk_bf16_f32 v129, v42, v43
    v_cvt_pk_bf16_f32 v110, v36, v37
    v_cvt_pk_bf16_f32 v130, v44, v45
    v_cvt_pk_bf16_f32 v111, v38, v39
    v_cvt_pk_bf16_f32 v131, v46, v47
    v_cndmask_b32 v110, v110, 0, s[66:67]
    v_cndmask_b32 v130, v130, 0, s[66:67]
    v_cndmask_b32 v111, v111, 0, s[66:67]
    v_cndmask_b32 v131, v131, 0, s[66:67]
    v_min_u32 v108, -2, v108
    v_min_u32 v128, -2, v128
    v_min_u32 v109, -2, v109
    v_min_u32 v129, -2, v129
    v_min_u32 v110, -2, v110
    v_min_u32 v130, -2, v130
    v_min_u32 v111, -2, v111
    v_min_u32 v131, -2, v131
    buffer_store_dwordx4 v[108:111], v8, s[16:19], 0 offen sc1
    buffer_store_dwordx4 v[128:131], v8, s[16:19], s5 offen sc1
    s_barrier
    s_and_b32 s50, s43, 3
    s_lshr_b32 s51, s43, 2
    s_lshl_b32 s71, s44, 2
    s_add_u32 s71, s71, s50
    s_lshl_b32 s52, s71, 14
    s_lshl_b32 s53, s51, 13
    s_add_u32 s52, s52, s53
    v_add_u32 v4, s52, v3
    s_lshl_b32 s71, s71, 4
    v_add_u32 v5, s71, v1
    v_bfe_u32 v160, v0, 2, 2
    v_lshl_add_u32 v160, v2, 2, v160
    v_bfe_u32 v161, v160, 1, 2
    v_and_b32 v153, 3, v0
    v_lshlrev_b32 v153, 3, v153
    v_lshl_add_u32 v153, v160, 7, v153
    s_mul_i32 s71, s51, 28672
    s_add_u32 s71, s71, 58368
    v_add_u32 v153, s71, v153
    s_lshl_b32 s71, s51, 1
    v_xor_b32 v161, s71, v161
    v_xor_b32 v160, 0, v161
    v_lshl_add_u32 v12, v160, 5, v153
    v_xor_b32 v160, 1, v161
    v_lshl_add_u32 v13, v160, 5, v153
    v_xor_b32 v160, 2, v161
    v_lshl_add_u32 v14, v160, 5, v153
    v_xor_b32 v160, 3, v161
    v_lshl_add_u32 v15, v160, 5, v153
    v_add_u32 v7, 4096, v4
    v_lshlrev_b32 v9, 2, v5
    v_add_u32 v9, 5242880, v9
    s_nop 1
    s_branch L_p3
L_A_halo:
    s_waitcnt lgkmcnt(0)
    s_mov_b32 s8, s72
    s_and_b32 s9, s73, 0xffff
    s_mov_b32 s10, 1835008
    s_mov_b32 s11, 0x20000
    s_cmp_eq_u32 s42, 0
    s_cselect_b32 s47, s74, s80
    s_cselect_b32 s48, s75, s81
    s_mov_b32 s12, s47
    s_and_b32 s13, s48, 0xffff
    s_mov_b32 s14, 1204224
    s_mov_b32 s15, 0x20000
    s_mov_b32 s71, 25088
    s_cmp_eq_u32 s42, 0
    s_cselect_b32 s47, s86, s82
    s_cselect_b32 s48, s87, s83
    s_cselect_b32 s71, 896, s71
    s_mov_b32 s24, s47
    s_and_b32 s25, s48, 0xffff
    s_mov_b32 s26, s71
    s_mov_b32 s27, 0x20000
    s_mov_b32 s16, s92
    s_and_b32 s17, s93, 0xffff
    s_mov_b32 s18, 16777216
    s_mov_b32 s19, 0x20000
    s_mov_b32 s28, s76
    s_and_b32 s29, s77, 0xffff
    s_mov_b32 s30, 401408
    s_mov_b32 s31, 0x20000
    s_mov_b32 s32, s84
    s_and_b32 s33, s85, 0xffff
    s_mov_b32 s34, 401408
    s_mov_b32 s35, 0x20000
    s_mov_b32 s36, s88
    s_and_b32 s37, s89, 0xffff
    s_mov_b32 s38, 1835008
    s_mov_b32 s39, 0x20000
    s_mov_b32 s20, s90
    s_and_b32 s21, s91, 0xffff
    s_mov_b32 s22, 256
    s_mov_b32 s23, 0x20000
    v_bfe_u32 v152, v0, 2, 2
    v_and_b32 v153, 3, v0
    v_lshlrev_b32 v154, 3, v2
    v_lshl_add_u32 v154, v152, 1, v154
    v_mul_u32_u24 v154, 112, v154
    v_lshl_add_u32 v6, v153, 3, v154
    s_mul_i32 s47, s4, 56
    v_add_u32 v6, s47, v6
    v_lshrrev_b32 v152, 1, v1
    v_xor_b32 v152, v152, v2
    v_lshlrev_b32 v152, 4, v152
    v_lshl_add_u32 v152, v1, 7, v152
    s_lshl_b32 s47, s3, 12
    v_add_u32 v4, s47, v152
    v_xor_b32 v5, 64, v4
    s_lshl_b32 s47, s40, 3
    s_lshl_b32 s48, s3, 1
    s_add_u32 s47, s47, s48
    s_lshl_b32 s47, s47, 4
    s_lshl_b32 s48, s41, 1
    s_add_u32 s47, s47, s48
    s_add_u32 s47, s47, s4
    s_lshl_b32 s47, s47, 10
    s_lshl_b32 s48, s42, 21
    s_add_u32 s47, s47, s48
    v_add_u32 v8, s47, v3
    s_mov_b32 s5, 16384
    v_mov_b32 v156, -1
    v_mov_b32 v157, -1
    v_mov_b32 v158, -1
    v_mov_b32 v159, -1
    s_lshl_b32 s47, s41, 4
    s_add_u32 s47, s47, s40
    s_lshl_b32 s47, s47, 3
    s_add_u32 s47, s47, s43
    s_lshl_b32 s47, s47, 10
    s_add_u32 s47, s47, 4194304
    v_add_u32 v9, s47, v3
    buffer_store_dwordx4 v[156:159], v9, s[16:19], 0 offen sc1
    s_barrier
    s_cmp_ge_u32 s43, 6
    s_cbranch_scc1 L_pfx_9
    s_cmp_lt_u32 s43, 3
    s_cselect_b32 s47, s74, s80
    s_cselect_b32 s48, s75, s81
    s_cselect_b32 s71, 0, 3
    s_mov_b32 s52, s47
    s_and_b32 s53, s48, 0xffff
    s_mov_b32 s54, 1204224
    s_mov_b32 s55, 0x20000
    s_sub_u32 s71, s43, s71
    s_lshl_b32 s71, s71, 6
    v_add_u32 v152, s71, v0
    v_mul_u32_u24 v153, 5462, v152
    v_lshrrev_b32 v153, 16, v153
    v_mul_u32_u24 v154, 12, v153
    v_sub_u32 v154, v152, v154
    v_lshrrev_b32 v155, 2, v154
    v_and_b32 v154, 3, v154
    s_mul_i32 s71, s46, 14
    v_add_u32 v153, s71, v153
    v_mul_u32_u24 v153, 2688, v153
    v_mul_u32_u24 v155, 896, v155
    v_lshl_add_u32 v154, v154, 7, v155
    s_lshr_b32 s71, s41, 2
    s_mul_i32 s71, s71, 384
    v_add3_u32 v153, v153, v154, s71
    v_mov_b32 v154, 0x1000000
    v_cmp_gt_u32 vcc, 168, v152
    s_nop 1
    v_cndmask_b32 v153, v154, v153, vcc
    buffer_load_dword v15, v153, s[52:55], 0 offen
    s_nop 0
    s_branch L_pfd_10
L_pfx_9:
    s_sub_u32 s71, s43, 6
    s_lshl_b32 s71, s71, 6
    v_add_u32 v152, s71, v0
    s_mul_i32 s71, s46, 112
    s_lshr_b32 s48, s40, 2
    s_mul_i32 s48, s48, 3584
    s_add_u32 s71, s71, s48
    v_add_u32 v153, s71, v152
    v_lshlrev_b32 v153, 7, v153
    v_mov_b32 v154, 0x1000000
    v_cmp_gt_u32 vcc, 112, v152
    s_nop 1
    v_cndmask_b32 v153, v154, v153, vcc
    s_waitcnt vmcnt(0)
    buffer_load_dword v15, v153, s[8:11], 0 offen
L_pfd_10:
    s_mov_b32 s50, 0x50000
    s_mov_b32 s51, 0x5550055
    s_mov_b32 s52, 0xa0000
    s_mov_b32 s53, 0xaaa00aa
    s_mov_b32 s54, 0x150001
    s_mov_b32 s55, 0x15550155
    s_mov_b32 s56, 0x2a0002
    s_mov_b32 s57, 0x2aaa02aa
    s_mov_b32 s58, 0x55505555
    s_mov_b32 s59, 0x50005500
    s_mov_b32 s60, 0xaaa0aaaa
    s_mov_b32 s61, 0xa000aa00
    s_mov_b32 s62, 0x55405554
    s_mov_b32 s63, 0x40005400
    s_mov_b32 s64, 0xaa80aaa8
    s_mov_b32 s65, 0x8000a800
    s_lshl_b32 s47, s43, 11
    s_add_u32 s47, s47, 116736
    v_add_u32 v10, s47, v3
    v_lshl_add_u32 v11, v0, 3, s47
    s_waitcnt vmcnt(1)
    s_barrier
    ds_read_b128 v[80:83], v4 offset:0
    ds_read_b128 v[84:87], v4 offset:2048
    ds_read_b128 v[88:91], v4 offset:16384
    ds_read_b64_tr_b16 v[92:93], v6 offset:18432
    ds_read_b64_tr_b16 v[94:95], v6 offset:18544
    ds_read_b64_tr_b16 v[96:97], v6 offset:18464
    ds_read_b64_tr_b16 v[98:99], v6 offset:18576
    ds_read_b64_tr_b16 v[100:101], v6 offset:25600
    ds_read_b64_tr_b16 v[102:103], v6 offset:25712
    ds_read_b64_tr_b16 v[104:105], v6 offset:25632
    ds_read_b64_tr_b16 v[106:107], v6 offset:25744
    ds_read_b64_tr_b16 v[108:109], v6 offset:32768
    ds_read_b64_tr_b16 v[110:111], v6 offset:32880
    ds_read_b64_tr_b16 v[112:113], v6 offset:32800
    ds_read_b64_tr_b16 v[114:115], v6 offset:32912
    s_waitcnt lgkmcnt(11)
    ds_read_b128 v[116:119], v5 offset:0
    ds_read_b128 v[120:123], v5 offset:2048
    s_waitcnt lgkmcnt(12)
    v_mfma_f32_16x16x32_bf16 v[16:19], v[92:95], v[80:83], 0
    ds_read_b128 v[124:127], v5 offset:16384
    v_mfma_f32_16x16x32_bf16 v[24:27], v[92:95], v[84:87], 0
    ds_read_b64_tr_b16 v[128:129], v6 offset:22016
    v_mfma_f32_16x16x32_bf16 v[64:67], v[92:95], v[88:91], 0
    ds_read_b64_tr_b16 v[130:131], v6 offset:22128
    s_waitcnt lgkmcnt(13)
    v_mfma_f32_16x16x32_bf16 v[20:23], v[96:99], v[80:83], 0
    ds_read_b64_tr_b16 v[132:133], v6 offset:22048
    ds_read_b64_tr_b16 v[134:135], v6 offset:22160
    v_mfma_f32_16x16x32_bf16 v[28:31], v[96:99], v[84:87], 0
    s_waitcnt lgkmcnt(11)
    ds_read_b64_tr_b16 v[136:137], v6 offset:29184
    v_mfma_f32_16x16x32_bf16 v[68:71], v[96:99], v[88:91], 0
    ds_read_b64_tr_b16 v[138:139], v6 offset:29296
    v_mfma_f32_16x16x32_bf16 v[32:35], v[80:83], v[100:103], 0
    ds_read_b64_tr_b16 v[140:141], v6 offset:29216
    v_mfma_f32_16x16x32_bf16 v[40:43], v[84:87], v[100:103], 0
    ds_read_b64_tr_b16 v[142:143], v6 offset:29328
    s_waitcnt lgkmcnt(11)
    ds_read_b64_tr_b16 v[144:145], v6 offset:36352
    v_mfma_f32_16x16x32_bf16 v[72:75], v[88:91], v[100:103], 0
    ds_read_b64_tr_b16 v[146:147], v6 offset:36464
    v_mfma_f32_16x16x32_bf16 v[36:39], v[80:83], v[104:107], 0
    ds_read_b64_tr_b16 v[148:149], v6 offset:36384
    v_mfma_f32_16x16x32_bf16 v[44:47], v[84:87], v[104:107], 0
    ds_read_b64_tr_b16 v[150:151], v6 offset:36496
    v_mfma_f32_16x16x32_bf16 v[76:79], v[88:91], v[104:107], 0
    v_mfma_f32_16x16x32_bf16 v[48:51], v[108:111], v[80:83], 0
    v_mfma_f32_16x16x32_bf16 v[56:59], v[108:111], v[84:87], 0
    v_mfma_f32_16x16x32_bf16 v[52:55], v[112:115], v[80:83], 0
    v_mfma_f32_16x16x32_bf16 v[60:63], v[112:115], v[84:87], 0
    s_waitcnt lgkmcnt(10)
    v_mfma_f32_16x16x32_bf16 v[16:19], v[128:131], v[116:119], v[16:19]
    v_mfma_f32_16x16x32_bf16 v[24:27], v[128:131], v[120:123], v[24:27]
    s_cmp_lg_u32 s43, 0
    s_nop 6
    s_cbranch_scc1 L_fs_11
    s_lshl_b32 s47, s40, 3
    s_add_u32 s47, s47, s41
    v_mov_b32 v152, s47
    v_mov_b32 v153, 1
    s_mov_b64 exec, 1
    buffer_store_byte v153, v152, s[20:23], 0 offen sc1
    s_mov_b64 exec, -1
L_fs_11:
    s_mov_b32 s47, 2097152
    buffer_store_dwordx4 v[156:159], v8, s[16:19], s47 offen sc1
    buffer_store_dwordx4 v[156:159], v8, s[16:19], 0 offen sc1
    s_barrier
    v_add_u32 v4, 0x9c00, v4
    v_add_u32 v5, 0x9c00, v5
    v_add_u32 v6, 0x9c00, v6
    ds_read_b128 v[80:83], v4 offset:0
    ds_read_b128 v[84:87], v4 offset:2048
    v_mfma_f32_16x16x32_bf16 v[64:67], v[128:131], v[124:127], v[64:67]
    ds_read_b128 v[88:91], v4 offset:16384
    s_waitcnt lgkmcnt(11)
    v_mfma_f32_16x16x32_bf16 v[20:23], v[132:135], v[116:119], v[20:23]
    ds_read_b64_tr_b16 v[92:93], v6 offset:18432
    ds_read_b64_tr_b16 v[94:95], v6 offset:18544
    v_mfma_f32_16x16x32_bf16 v[28:31], v[132:135], v[120:123], v[28:31]
    ds_read_b64_tr_b16 v[96:97], v6 offset:18464
    v_mfma_f32_16x16x32_bf16 v[68:71], v[132:135], v[124:127], v[68:71]
    ds_read_b64_tr_b16 v[98:99], v6 offset:18576
    s_waitcnt lgkmcnt(11)
    ds_read_b64_tr_b16 v[100:101], v6 offset:25600
    v_mfma_f32_16x16x32_bf16 v[32:35], v[116:119], v[136:139], v[32:35]
    ds_read_b64_tr_b16 v[102:103], v6 offset:25712
    v_mfma_f32_16x16x32_bf16 v[40:43], v[120:123], v[136:139], v[40:43]
    ds_read_b64_tr_b16 v[104:105], v6 offset:25632
    ds_read_b64_tr_b16 v[106:107], v6 offset:25744
    v_mfma_f32_16x16x32_bf16 v[72:75], v[124:127], v[136:139], v[72:75]
    s_waitcnt lgkmcnt(11)
    ds_read_b64_tr_b16 v[108:109], v6 offset:32768
    v_mfma_f32_16x16x32_bf16 v[36:39], v[116:119], v[140:143], v[36:39]
    ds_read_b64_tr_b16 v[110:111], v6 offset:32880
    ds_read_b64_tr_b16 v[112:113], v6 offset:32800
    v_mfma_f32_16x16x32_bf16 v[44:47], v[120:123], v[140:143], v[44:47]
    ds_read_b64_tr_b16 v[114:115], v6 offset:32912
    v_mfma_f32_16x16x32_bf16 v[76:79], v[124:127], v[140:143], v[76:79]
    v_mfma_f32_16x16x32_bf16 v[48:51], v[144:147], v[116:119], v[48:51]
    v_mfma_f32_16x16x32_bf16 v[56:59], v[144:147], v[120:123], v[56:59]
    v_mfma_f32_16x16x32_bf16 v[52:55], v[148:151], v[116:119], v[52:55]
    v_mfma_f32_16x16x32_bf16 v[60:63], v[148:151], v[120:123], v[60:63]
    s_waitcnt lgkmcnt(11)
    ds_read_b128 v[116:119], v5 offset:0
    ds_read_b128 v[120:123], v5 offset:2048
    s_waitcnt lgkmcnt(12)
    v_mfma_f32_16x16x32_bf16 v[16:19], v[92:95], v[80:83], v[16:19]
    ds_read_b128 v[124:127], v5 offset:16384
    v_mfma_f32_16x16x32_bf16 v[24:27], v[92:95], v[84:87], v[24:27]
    ds_read_b64_tr_b16 v[128:129], v6 offset:22016
    v_mfma_f32_16x16x32_bf16 v[64:67], v[92:95], v[88:91], v[64:67]
    ds_read_b64_tr_b16 v[130:131], v6 offset:22128
    s_waitcnt lgkmcnt(13)
    v_mfma_f32_16x16x32_bf16 v[20:23], v[96:99], v[80:83], v[20:23]
    ds_read_b64_tr_b16 v[132:133], v6 offset:22048
    ds_read_b64_tr_b16 v[134:135], v6 offset:22160
    v_mfma_f32_16x16x32_bf16 v[28:31], v[96:99], v[84:87], v[28:31]
    s_waitcnt lgkmcnt(11)
    ds_read_b64_tr_b16 v[136:137], v6 offset:29184
    v_mfma_f32_16x16x32_bf16 v[68:71], v[96:99], v[88:91], v[68:71]
    ds_read_b64_tr_b16 v[138:139], v6 offset:29296
    v_mfma_f32_16x16x32_bf16 v[32:35], v[80:83], v[100:103], v[32:35]
    ds_read_b64_tr_b16 v[140:141], v6 offset:29216
    v_mfma_f32_16x16x32_bf16 v[40:43], v[84:87], v[100:103], v[40:43]
    ds_read_b64_tr_b16 v[142:143], v6 offset:29328
    s_waitcnt lgkmcnt(11)
    ds_read_b64_tr_b16 v[144:145], v6 offset:36352
    v_mfma_f32_16x16x32_bf16 v[72:75], v[88:91], v[100:103], v[72:75]
    ds_read_b64_tr_b16 v[146:147], v6 offset:36464
    v_mfma_f32_16x16x32_bf16 v[36:39], v[80:83], v[104:107], v[36:39]
    ds_read_b64_tr_b16 v[148:149], v6 offset:36384
    v_mfma_f32_16x16x32_bf16 v[44:47], v[84:87], v[104:107], v[44:47]
    ds_read_b64_tr_b16 v[150:151], v6 offset:36496
    v_mfma_f32_16x16x32_bf16 v[76:79], v[88:91], v[104:107], v[76:79]
    v_mfma_f32_16x16x32_bf16 v[48:51], v[108:111], v[80:83], v[48:51]
    v_mfma_f32_16x16x32_bf16 v[56:59], v[108:111], v[84:87], v[56:59]
    v_mfma_f32_16x16x32_bf16 v[52:55], v[112:115], v[80:83], v[52:55]
    v_mfma_f32_16x16x32_bf16 v[60:63], v[112:115], v[84:87], v[60:63]
    s_waitcnt lgkmcnt(10)
    v_mfma_f32_16x16x32_bf16 v[16:19], v[128:131], v[116:119], v[16:19]
    v_mfma_f32_16x16x32_bf16 v[24:27], v[128:131], v[120:123], v[24:27]
    s_mov_b32 s47, 2113536
    buffer_store_dwordx4 v[156:159], v8, s[16:19], s47 offen sc1
    buffer_store_dwordx4 v[156:159], v8, s[16:19], s5 offen sc1
    s_barrier
    v_add_u32 v4, 0x9c00, v4
    v_add_u32 v5, 0x9c00, v5
    v_add_u32 v6, 0x9c00, v6
    ds_read_b128 v[80:83], v4 offset:0
    ds_read_b128 v[84:87], v4 offset:2048
    v_mfma_f32_16x16x32_bf16 v[64:67], v[128:131], v[124:127], v[64:67]
    ds_read_b128 v[88:91], v4 offset:16384
    s_waitcnt lgkmcnt(11)
    v_mfma_f32_16x16x32_bf16 v[20:23], v[132:135], v[116:119], v[20:23]
    ds_read_b64_tr_b16 v[92:93], v6 offset:18432
    ds_read_b64_tr_b16 v[94:95], v6 offset:18544
    v_mfma_f32_16x16x32_bf16 v[28:31], v[132:135], v[120:123], v[28:31]
    ds_read_b64_tr_b16 v[96:97], v6 offset:18464
    v_mfma_f32_16x16x32_bf16 v[68:71], v[132:135], v[124:127], v[68:71]
    ds_read_b64_tr_b16 v[98:99], v6 offset:18576
    s_waitcnt lgkmcnt(11)
    ds_read_b64_tr_b16 v[100:101], v6 offset:25600
    v_mfma_f32_16x16x32_bf16 v[32:35], v[116:119], v[136:139], v[32:35]
    ds_read_b64_tr_b16 v[102:103], v6 offset:25712
    v_mfma_f32_16x16x32_bf16 v[40:43], v[120:123], v[136:139], v[40:43]
    ds_read_b64_tr_b16 v[104:105], v6 offset:25632
    ds_read_b64_tr_b16 v[106:107], v6 offset:25744
    v_mfma_f32_16x16x32_bf16 v[72:75], v[124:127], v[136:139], v[72:75]
    s_waitcnt lgkmcnt(11)
    ds_read_b64_tr_b16 v[108:109], v6 offset:32768
    v_mfma_f32_16x16x32_bf16 v[36:39], v[116:119], v[140:143], v[36:39]
    ds_read_b64_tr_b16 v[110:111], v6 offset:32880
    ds_read_b64_tr_b16 v[112:113], v6 offset:32800
    v_mfma_f32_16x16x32_bf16 v[44:47], v[120:123], v[140:143], v[44:47]
    ds_read_b64_tr_b16 v[114:115], v6 offset:32912
    v_mfma_f32_16x16x32_bf16 v[76:79], v[124:127], v[140:143], v[76:79]
    v_mfma_f32_16x16x32_bf16 v[48:51], v[144:147], v[116:119], v[48:51]
    v_mfma_f32_16x16x32_bf16 v[56:59], v[144:147], v[120:123], v[56:59]
    v_mfma_f32_16x16x32_bf16 v[52:55], v[148:151], v[116:119], v[52:55]
    v_mfma_f32_16x16x32_bf16 v[60:63], v[148:151], v[120:123], v[60:63]
    s_waitcnt lgkmcnt(11)
    ds_read_b128 v[116:119], v5 offset:0
    ds_read_b128 v[120:123], v5 offset:2048
    s_waitcnt lgkmcnt(12)
    v_mfma_f32_16x16x32_bf16 v[16:19], v[92:95], v[80:83], v[16:19]
    ds_read_b128 v[124:127], v5 offset:16384
    v_mfma_f32_16x16x32_bf16 v[24:27], v[92:95], v[84:87], v[24:27]
    ds_read_b64_tr_b16 v[128:129], v6 offset:22016
    v_mfma_f32_16x16x32_bf16 v[64:67], v[92:95], v[88:91], v[64:67]
    ds_read_b64_tr_b16 v[130:131], v6 offset:22128
    s_waitcnt lgkmcnt(13)
    v_mfma_f32_16x16x32_bf16 v[20:23], v[96:99], v[80:83], v[20:23]
    ds_read_b64_tr_b16 v[132:133], v6 offset:22048
    ds_read_b64_tr_b16 v[134:135], v6 offset:22160
    v_mfma_f32_16x16x32_bf16 v[28:31], v[96:99], v[84:87], v[28:31]
    s_waitcnt lgkmcnt(11)
    ds_read_b64_tr_b16 v[136:137], v6 offset:29184
    v_mfma_f32_16x16x32_bf16 v[68:71], v[96:99], v[88:91], v[68:71]
    ds_read_b64_tr_b16 v[138:139], v6 offset:29296
    v_mfma_f32_16x16x32_bf16 v[32:35], v[80:83], v[100:103], v[32:35]
    ds_read_b64_tr_b16 v[140:141], v6 offset:29216
    v_mfma_f32_16x16x32_bf16 v[40:43], v[84:87], v[100:103], v[40:43]
    ds_read_b64_tr_b16 v[142:143], v6 offset:29328
    s_waitcnt lgkmcnt(11)
    ds_read_b64_tr_b16 v[144:145], v6 offset:36352
    v_mfma_f32_16x16x32_bf16 v[72:75], v[88:91], v[100:103], v[72:75]
    ds_read_b64_tr_b16 v[146:147], v6 offset:36464
    v_mfma_f32_16x16x32_bf16 v[36:39], v[80:83], v[104:107], v[36:39]
    ds_read_b64_tr_b16 v[148:149], v6 offset:36384
    v_mfma_f32_16x16x32_bf16 v[44:47], v[84:87], v[104:107], v[44:47]
    ds_read_b64_tr_b16 v[150:151], v6 offset:36496
    v_mfma_f32_16x16x32_bf16 v[76:79], v[88:91], v[104:107], v[76:79]
    v_mfma_f32_16x16x32_bf16 v[48:51], v[108:111], v[80:83], v[48:51]
    v_mfma_f32_16x16x32_bf16 v[56:59], v[108:111], v[84:87], v[56:59]
    v_mfma_f32_16x16x32_bf16 v[52:55], v[112:115], v[80:83], v[52:55]
    v_mfma_f32_16x16x32_bf16 v[60:63], v[112:115], v[84:87], v[60:63]
    s_waitcnt lgkmcnt(10)
    v_mfma_f32_16x16x32_bf16 v[16:19], v[128:131], v[116:119], v[16:19]
    v_mfma_f32_16x16x32_bf16 v[24:27], v[128:131], v[120:123], v[24:27]
    s_barrier
    v_add_u32 v4, 0x9c00, v4
    v_add_u32 v5, 0x9c00, v5
    v_add_u32 v6, 0x9c00, v6
    ds_read_b128 v[80:83], v4 offset:0
    ds_read_b128 v[84:87], v4 offset:2048
    v_mfma_f32_16x16x32_bf16 v[64:67], v[128:131], v[124:127], v[64:67]
    ds_read_b128 v[88:91], v4 offset:16384
    s_waitcnt lgkmcnt(11)
    v_mfma_f32_16x16x32_bf16 v[20:23], v[132:135], v[116:119], v[20:23]
    ds_read_b64_tr_b16 v[92:93], v6 offset:18432
    ds_read_b64_tr_b16 v[94:95], v6 offset:18544
    v_mfma_f32_16x16x32_bf16 v[28:31], v[132:135], v[120:123], v[28:31]
    ds_read_b64_tr_b16 v[96:97], v6 offset:18464
    v_mfma_f32_16x16x32_bf16 v[68:71], v[132:135], v[124:127], v[68:71]
    ds_read_b64_tr_b16 v[98:99], v6 offset:18576
    s_waitcnt lgkmcnt(11)
    ds_read_b64_tr_b16 v[100:101], v6 offset:25600
    v_mfma_f32_16x16x32_bf16 v[32:35], v[116:119], v[136:139], v[32:35]
    ds_read_b64_tr_b16 v[102:103], v6 offset:25712
    v_mfma_f32_16x16x32_bf16 v[40:43], v[120:123], v[136:139], v[40:43]
    ds_read_b64_tr_b16 v[104:105], v6 offset:25632
    ds_read_b64_tr_b16 v[106:107], v6 offset:25744
    v_mfma_f32_16x16x32_bf16 v[72:75], v[124:127], v[136:139], v[72:75]
    s_waitcnt lgkmcnt(11)
    ds_read_b64_tr_b16 v[108:109], v6 offset:32768
    v_mfma_f32_16x16x32_bf16 v[36:39], v[116:119], v[140:143], v[36:39]
    ds_read_b64_tr_b16 v[110:111], v6 offset:32880
    ds_read_b64_tr_b16 v[112:113], v6 offset:32800
    v_mfma_f32_16x16x32_bf16 v[44:47], v[120:123], v[140:143], v[44:47]
    ds_read_b64_tr_b16 v[114:115], v6 offset:32912
    v_mfma_f32_16x16x32_bf16 v[76:79], v[124:127], v[140:143], v[76:79]
    v_mfma_f32_16x16x32_bf16 v[48:51], v[144:147], v[116:119], v[48:51]
    v_mfma_f32_16x16x32_bf16 v[56:59], v[144:147], v[120:123], v[56:59]
    v_mfma_f32_16x16x32_bf16 v[52:55], v[148:151], v[116:119], v[52:55]
    v_mfma_f32_16x16x32_bf16 v[60:63], v[148:151], v[120:123], v[60:63]
    s_waitcnt lgkmcnt(11)
    ds_read_b128 v[116:119], v5 offset:0
    ds_read_b128 v[120:123], v5 offset:2048
    s_waitcnt lgkmcnt(12)
    v_mfma_f32_16x16x32_bf16 v[16:19], v[92:95], v[80:83], v[16:19]
    ds_read_b128 v[124:127], v5 offset:16384
    v_mfma_f32_16x16x32_bf16 v[24:27], v[92:95], v[84:87], v[24:27]
    ds_read_b64_tr_b16 v[128:129], v6 offset:22016
    v_mfma_f32_16x16x32_bf16 v[64:67], v[92:95], v[88:91], v[64:67]
    ds_read_b64_tr_b16 v[130:131], v6 offset:22128
    s_waitcnt lgkmcnt(13)
    v_mfma_f32_16x16x32_bf16 v[20:23], v[96:99], v[80:83], v[20:23]
    ds_read_b64_tr_b16 v[132:133], v6 offset:22048
    ds_read_b64_tr_b16 v[134:135], v6 offset:22160
    v_mfma_f32_16x16x32_bf16 v[28:31], v[96:99], v[84:87], v[28:31]
    s_waitcnt lgkmcnt(11)
    ds_read_b64_tr_b16 v[136:137], v6 offset:29184
    v_mfma_f32_16x16x32_bf16 v[68:71], v[96:99], v[88:91], v[68:71]
    ds_read_b64_tr_b16 v[138:139], v6 offset:29296
    v_mfma_f32_16x16x32_bf16 v[32:35], v[80:83], v[100:103], v[32:35]
    ds_read_b64_tr_b16 v[140:141], v6 offset:29216
    v_mfma_f32_16x16x32_bf16 v[40:43], v[84:87], v[100:103], v[40:43]
    ds_read_b64_tr_b16 v[142:143], v6 offset:29328
    s_waitcnt lgkmcnt(11)
    ds_read_b64_tr_b16 v[144:145], v6 offset:36352
    v_mfma_f32_16x16x32_bf16 v[72:75], v[88:91], v[100:103], v[72:75]
    ds_read_b64_tr_b16 v[146:147], v6 offset:36464
    v_mfma_f32_16x16x32_bf16 v[36:39], v[80:83], v[104:107], v[36:39]
    ds_read_b64_tr_b16 v[148:149], v6 offset:36384
    v_mfma_f32_16x16x32_bf16 v[44:47], v[84:87], v[104:107], v[44:47]
    ds_read_b64_tr_b16 v[150:151], v6 offset:36496
    v_mfma_f32_16x16x32_bf16 v[76:79], v[88:91], v[104:107], v[76:79]
    v_mfma_f32_16x16x32_bf16 v[48:51], v[108:111], v[80:83], v[48:51]
    v_mfma_f32_16x16x32_bf16 v[56:59], v[108:111], v[84:87], v[56:59]
    v_mfma_f32_16x16x32_bf16 v[52:55], v[112:115], v[80:83], v[52:55]
    v_mfma_f32_16x16x32_bf16 v[60:63], v[112:115], v[84:87], v[60:63]
    s_waitcnt lgkmcnt(10)
    v_mfma_f32_16x16x32_bf16 v[16:19], v[128:131], v[116:119], v[16:19]
    v_mfma_f32_16x16x32_bf16 v[24:27], v[128:131], v[120:123], v[24:27]
    s_barrier
    v_add_u32 v4, 0xfffe2c00, v4
    v_add_u32 v5, 0xfffe2c00, v5
    v_add_u32 v6, 0xfffe2c00, v6
    ds_read_b128 v[80:83], v4 offset:0
    ds_read_b128 v[84:87], v4 offset:2048
    v_mfma_f32_16x16x32_bf16 v[64:67], v[128:131], v[124:127], v[64:67]
    ds_read_b128 v[88:91], v4 offset:16384
    s_waitcnt lgkmcnt(11)
    v_mfma_f32_16x16x32_bf16 v[20:23], v[132:135], v[116:119], v[20:23]
    ds_read_b64_tr_b16 v[92:93], v6 offset:18432
    ds_read_b64_tr_b16 v[94:95], v6 offset:18544
    v_mfma_f32_16x16x32_bf16 v[28:31], v[132:135], v[120:123], v[28:31]
    ds_read_b64_tr_b16 v[96:97], v6 offset:18464
    v_mfma_f32_16x16x32_bf16 v[68:71], v[132:135], v[124:127], v[68:71]
    ds_read_b64_tr_b16 v[98:99], v6 offset:18576
    s_waitcnt lgkmcnt(11)
    ds_read_b64_tr_b16 v[100:101], v6 offset:25600
    v_mfma_f32_16x16x32_bf16 v[32:35], v[116:119], v[136:139], v[32:35]
    ds_read_b64_tr_b16 v[102:103], v6 offset:25712
    v_mfma_f32_16x16x32_bf16 v[40:43], v[120:123], v[136:139], v[40:43]
    ds_read_b64_tr_b16 v[104:105], v6 offset:25632
    ds_read_b64_tr_b16 v[106:107], v6 offset:25744
    v_mfma_f32_16x16x32_bf16 v[72:75], v[124:127], v[136:139], v[72:75]
    s_waitcnt lgkmcnt(11)
    ds_read_b64_tr_b16 v[108:109], v6 offset:32768
    v_mfma_f32_16x16x32_bf16 v[36:39], v[116:119], v[140:143], v[36:39]
    ds_read_b64_tr_b16 v[110:111], v6 offset:32880
    ds_read_b64_tr_b16 v[112:113], v6 offset:32800
    v_mfma_f32_16x16x32_bf16 v[44:47], v[120:123], v[140:143], v[44:47]
    ds_read_b64_tr_b16 v[114:115], v6 offset:32912
    v_mfma_f32_16x16x32_bf16 v[76:79], v[124:127], v[140:143], v[76:79]
    v_mfma_f32_16x16x32_bf16 v[48:51], v[144:147], v[116:119], v[48:51]
    v_mfma_f32_16x16x32_bf16 v[56:59], v[144:147], v[120:123], v[56:59]
    v_mfma_f32_16x16x32_bf16 v[52:55], v[148:151], v[116:119], v[52:55]
    v_mfma_f32_16x16x32_bf16 v[60:63], v[148:151], v[120:123], v[60:63]
    s_waitcnt lgkmcnt(11)
    ds_read_b128 v[116:119], v5 offset:0
    ds_read_b128 v[120:123], v5 offset:2048
    s_waitcnt lgkmcnt(12)
    v_mfma_f32_16x16x32_bf16 v[16:19], v[92:95], v[80:83], v[16:19]
    ds_read_b128 v[124:127], v5 offset:16384
    v_mfma_f32_16x16x32_bf16 v[24:27], v[92:95], v[84:87], v[24:27]
    ds_read_b64_tr_b16 v[128:129], v6 offset:22016
    v_mfma_f32_16x16x32_bf16 v[64:67], v[92:95], v[88:91], v[64:67]
    ds_read_b64_tr_b16 v[130:131], v6 offset:22128
    s_waitcnt lgkmcnt(13)
    v_mfma_f32_16x16x32_bf16 v[20:23], v[96:99], v[80:83], v[20:23]
    ds_read_b64_tr_b16 v[132:133], v6 offset:22048
    ds_read_b64_tr_b16 v[134:135], v6 offset:22160
    v_mfma_f32_16x16x32_bf16 v[28:31], v[96:99], v[84:87], v[28:31]
    s_waitcnt lgkmcnt(11)
    ds_read_b64_tr_b16 v[136:137], v6 offset:29184
    v_mfma_f32_16x16x32_bf16 v[68:71], v[96:99], v[88:91], v[68:71]
    ds_read_b64_tr_b16 v[138:139], v6 offset:29296
    v_mfma_f32_16x16x32_bf16 v[32:35], v[80:83], v[100:103], v[32:35]
    ds_read_b64_tr_b16 v[140:141], v6 offset:29216
    v_mfma_f32_16x16x32_bf16 v[40:43], v[84:87], v[100:103], v[40:43]
    ds_read_b64_tr_b16 v[142:143], v6 offset:29328
    s_waitcnt lgkmcnt(11)
    ds_read_b64_tr_b16 v[144:145], v6 offset:36352
    v_mfma_f32_16x16x32_bf16 v[72:75], v[88:91], v[100:103], v[72:75]
    ds_read_b64_tr_b16 v[146:147], v6 offset:36464
    v_mfma_f32_16x16x32_bf16 v[36:39], v[80:83], v[104:107], v[36:39]
    ds_read_b64_tr_b16 v[148:149], v6 offset:36384
    v_mfma_f32_16x16x32_bf16 v[44:47], v[84:87], v[104:107], v[44:47]
    ds_read_b64_tr_b16 v[150:151], v6 offset:36496
    v_mfma_f32_16x16x32_bf16 v[76:79], v[88:91], v[104:107], v[76:79]
    v_mfma_f32_16x16x32_bf16 v[48:51], v[108:111], v[80:83], v[48:51]
    v_mfma_f32_16x16x32_bf16 v[56:59], v[108:111], v[84:87], v[56:59]
    v_mfma_f32_16x16x32_bf16 v[52:55], v[112:115], v[80:83], v[52:55]
    v_mfma_f32_16x16x32_bf16 v[60:63], v[112:115], v[84:87], v[60:63]
    s_waitcnt lgkmcnt(10)
    v_mfma_f32_16x16x32_bf16 v[16:19], v[128:131], v[116:119], v[16:19]
    v_mfma_f32_16x16x32_bf16 v[24:27], v[128:131], v[120:123], v[24:27]
    s_waitcnt vmcnt(0)
    s_barrier
    v_add_u32 v4, 0x9c00, v4
    v_add_u32 v5, 0x9c00, v5
    v_add_u32 v6, 0x9c00, v6
    ds_read_b128 v[80:83], v4 offset:0
    ds_read_b128 v[84:87], v4 offset:2048
    v_mfma_f32_16x16x32_bf16 v[64:67], v[128:131], v[124:127], v[64:67]
    ds_read_b128 v[88:91], v4 offset:16384
    s_waitcnt lgkmcnt(11)
    v_mfma_f32_16x16x32_bf16 v[20:23], v[132:135], v[116:119], v[20:23]
    ds_read_b64_tr_b16 v[92:93], v6 offset:18432
    ds_read_b64_tr_b16 v[94:95], v6 offset:18544
    v_mfma_f32_16x16x32_bf16 v[28:31], v[132:135], v[120:123], v[28:31]
    ds_read_b64_tr_b16 v[96:97], v6 offset:18464
    v_mfma_f32_16x16x32_bf16 v[68:71], v[132:135], v[124:127], v[68:71]
    ds_read_b64_tr_b16 v[98:99], v6 offset:18576
    s_waitcnt lgkmcnt(11)
    ds_read_b64_tr_b16 v[100:101], v6 offset:25600
    v_mfma_f32_16x16x32_bf16 v[32:35], v[116:119], v[136:139], v[32:35]
    ds_read_b64_tr_b16 v[102:103], v6 offset:25712
    v_mfma_f32_16x16x32_bf16 v[40:43], v[120:123], v[136:139], v[40:43]
    ds_read_b64_tr_b16 v[104:105], v6 offset:25632
    ds_read_b64_tr_b16 v[106:107], v6 offset:25744
    v_mfma_f32_16x16x32_bf16 v[72:75], v[124:127], v[136:139], v[72:75]
    s_waitcnt lgkmcnt(11)
    ds_read_b64_tr_b16 v[108:109], v6 offset:32768
    v_mfma_f32_16x16x32_bf16 v[36:39], v[116:119], v[140:143], v[36:39]
    ds_read_b64_tr_b16 v[110:111], v6 offset:32880
    ds_read_b64_tr_b16 v[112:113], v6 offset:32800
    v_mfma_f32_16x16x32_bf16 v[44:47], v[120:123], v[140:143], v[44:47]
    ds_read_b64_tr_b16 v[114:115], v6 offset:32912
    v_mfma_f32_16x16x32_bf16 v[76:79], v[124:127], v[140:143], v[76:79]
    v_mfma_f32_16x16x32_bf16 v[48:51], v[144:147], v[116:119], v[48:51]
    v_mfma_f32_16x16x32_bf16 v[56:59], v[144:147], v[120:123], v[56:59]
    v_mfma_f32_16x16x32_bf16 v[52:55], v[148:151], v[116:119], v[52:55]
    v_mfma_f32_16x16x32_bf16 v[60:63], v[148:151], v[120:123], v[60:63]
    s_waitcnt lgkmcnt(11)
    ds_read_b128 v[116:119], v5 offset:0
    ds_read_b128 v[120:123], v5 offset:2048
    s_waitcnt lgkmcnt(12)
    v_mfma_f32_16x16x32_bf16 v[16:19], v[92:95], v[80:83], v[16:19]
    ds_read_b128 v[124:127], v5 offset:16384
    v_mfma_f32_16x16x32_bf16 v[24:27], v[92:95], v[84:87], v[24:27]
    ds_read_b64_tr_b16 v[128:129], v6 offset:22016
    v_mfma_f32_16x16x32_bf16 v[64:67], v[92:95], v[88:91], v[64:67]
    ds_read_b64_tr_b16 v[130:131], v6 offset:22128
    s_waitcnt lgkmcnt(13)
    v_mfma_f32_16x16x32_bf16 v[20:23], v[96:99], v[80:83], v[20:23]
    ds_read_b64_tr_b16 v[132:133], v6 offset:22048
    ds_read_b64_tr_b16 v[134:135], v6 offset:22160
    v_mfma_f32_16x16x32_bf16 v[28:31], v[96:99], v[84:87], v[28:31]
    s_waitcnt lgkmcnt(11)
    ds_read_b64_tr_b16 v[136:137], v6 offset:29184
    v_mfma_f32_16x16x32_bf16 v[68:71], v[96:99], v[88:91], v[68:71]
    ds_read_b64_tr_b16 v[138:139], v6 offset:29296
    v_mfma_f32_16x16x32_bf16 v[32:35], v[80:83], v[100:103], v[32:35]
    ds_read_b64_tr_b16 v[140:141], v6 offset:29216
    v_mfma_f32_16x16x32_bf16 v[40:43], v[84:87], v[100:103], v[40:43]
    ds_read_b64_tr_b16 v[142:143], v6 offset:29328
    s_waitcnt lgkmcnt(11)
    ds_read_b64_tr_b16 v[144:145], v6 offset:36352
    v_mfma_f32_16x16x32_bf16 v[72:75], v[88:91], v[100:103], v[72:75]
    ds_read_b64_tr_b16 v[146:147], v6 offset:36464
    v_mfma_f32_16x16x32_bf16 v[36:39], v[80:83], v[104:107], v[36:39]
    ds_read_b64_tr_b16 v[148:149], v6 offset:36384
    v_mfma_f32_16x16x32_bf16 v[44:47], v[84:87], v[104:107], v[44:47]
    ds_read_b64_tr_b16 v[150:151], v6 offset:36496
    v_mfma_f32_16x16x32_bf16 v[76:79], v[88:91], v[104:107], v[76:79]
    v_mfma_f32_16x16x32_bf16 v[48:51], v[108:111], v[80:83], v[48:51]
    v_mfma_f32_16x16x32_bf16 v[56:59], v[108:111], v[84:87], v[56:59]
    v_mfma_f32_16x16x32_bf16 v[52:55], v[112:115], v[80:83], v[52:55]
    v_mfma_f32_16x16x32_bf16 v[60:63], v[112:115], v[84:87], v[60:63]
    s_waitcnt lgkmcnt(10)
    v_mfma_f32_16x16x32_bf16 v[16:19], v[128:131], v[116:119], v[16:19]
    v_mfma_f32_16x16x32_bf16 v[24:27], v[128:131], v[120:123], v[24:27]
    s_cmp_lg_u32 s43, 0
    s_nop 6
    s_cbranch_scc1 L_fs_12
    s_lshl_b32 s47, s40, 3
    s_add_u32 s47, s47, s41
    s_add_u32 s47, s47, 128
    v_mov_b32 v152, s47
    v_mov_b32 v153, 1
    s_mov_b64 exec, 1
    buffer_store_byte v153, v152, s[20:23], 0 offen sc1
    s_mov_b64 exec, -1
L_fs_12:
    s_barrier
    v_add_u32 v4, 0x9c00, v4
    v_add_u32 v5, 0x9c00, v5
    v_add_u32 v6, 0x9c00, v6
    ds_read_b128 v[80:83], v4 offset:0
    ds_read_b128 v[84:87], v4 offset:2048
    v_mfma_f32_16x16x32_bf16 v[64:67], v[128:131], v[124:127], v[64:67]
    ds_read_b128 v[88:91], v4 offset:16384
    s_waitcnt lgkmcnt(11)
    v_mfma_f32_16x16x32_bf16 v[20:23], v[132:135], v[116:119], v[20:23]
    ds_read_b64_tr_b16 v[92:93], v6 offset:18432
    ds_read_b64_tr_b16 v[94:95], v6 offset:18544
    v_mfma_f32_16x16x32_bf16 v[28:31], v[132:135], v[120:123], v[28:31]
    ds_read_b64_tr_b16 v[96:97], v6 offset:18464
    v_mfma_f32_16x16x32_bf16 v[68:71], v[132:135], v[124:127], v[68:71]
    ds_read_b64_tr_b16 v[98:99], v6 offset:18576
    s_waitcnt lgkmcnt(11)
    ds_read_b64_tr_b16 v[100:101], v6 offset:25600
    v_mfma_f32_16x16x32_bf16 v[32:35], v[116:119], v[136:139], v[32:35]
    ds_read_b64_tr_b16 v[102:103], v6 offset:25712
    v_mfma_f32_16x16x32_bf16 v[40:43], v[120:123], v[136:139], v[40:43]
    ds_read_b64_tr_b16 v[104:105], v6 offset:25632
    ds_read_b64_tr_b16 v[106:107], v6 offset:25744
    v_mfma_f32_16x16x32_bf16 v[72:75], v[124:127], v[136:139], v[72:75]
    s_waitcnt lgkmcnt(11)
    ds_read_b64_tr_b16 v[108:109], v6 offset:32768
    v_mfma_f32_16x16x32_bf16 v[36:39], v[116:119], v[140:143], v[36:39]
    ds_read_b64_tr_b16 v[110:111], v6 offset:32880
    ds_read_b64_tr_b16 v[112:113], v6 offset:32800
    v_mfma_f32_16x16x32_bf16 v[44:47], v[120:123], v[140:143], v[44:47]
    ds_read_b64_tr_b16 v[114:115], v6 offset:32912
    v_mfma_f32_16x16x32_bf16 v[76:79], v[124:127], v[140:143], v[76:79]
    v_mfma_f32_16x16x32_bf16 v[48:51], v[144:147], v[116:119], v[48:51]
    v_mfma_f32_16x16x32_bf16 v[56:59], v[144:147], v[120:123], v[56:59]
    v_mfma_f32_16x16x32_bf16 v[52:55], v[148:151], v[116:119], v[52:55]
    v_mfma_f32_16x16x32_bf16 v[60:63], v[148:151], v[120:123], v[60:63]
    s_waitcnt lgkmcnt(11)
    ds_read_b128 v[116:119], v5 offset:0
    ds_read_b128 v[120:123], v5 offset:2048
    s_waitcnt lgkmcnt(12)
    v_mfma_f32_16x16x32_bf16 v[16:19], v[92:95], v[80:83], v[16:19]
    ds_read_b128 v[124:127], v5 offset:16384
    v_mfma_f32_16x16x32_bf16 v[24:27], v[92:95], v[84:87], v[24:27]
    ds_read_b64_tr_b16 v[128:129], v6 offset:22016
    v_mfma_f32_16x16x32_bf16 v[64:67], v[92:95], v[88:91], v[64:67]
    ds_read_b64_tr_b16 v[130:131], v6 offset:22128
    s_waitcnt lgkmcnt(13)
    v_mfma_f32_16x16x32_bf16 v[20:23], v[96:99], v[80:83], v[20:23]
    ds_read_b64_tr_b16 v[132:133], v6 offset:22048
    ds_read_b64_tr_b16 v[134:135], v6 offset:22160
    v_mfma_f32_16x16x32_bf16 v[28:31], v[96:99], v[84:87], v[28:31]
    s_waitcnt lgkmcnt(11)
    ds_read_b64_tr_b16 v[136:137], v6 offset:29184
    v_mfma_f32_16x16x32_bf16 v[68:71], v[96:99], v[88:91], v[68:71]
    ds_read_b64_tr_b16 v[138:139], v6 offset:29296
    v_mfma_f32_16x16x32_bf16 v[32:35], v[80:83], v[100:103], v[32:35]
    ds_read_b64_tr_b16 v[140:141], v6 offset:29216
    v_mfma_f32_16x16x32_bf16 v[40:43], v[84:87], v[100:103], v[40:43]
    ds_read_b64_tr_b16 v[142:143], v6 offset:29328
    s_waitcnt lgkmcnt(11)
    ds_read_b64_tr_b16 v[144:145], v6 offset:36352
    v_mfma_f32_16x16x32_bf16 v[72:75], v[88:91], v[100:103], v[72:75]
    ds_read_b64_tr_b16 v[146:147], v6 offset:36464
    v_mfma_f32_16x16x32_bf16 v[36:39], v[80:83], v[104:107], v[36:39]
    ds_read_b64_tr_b16 v[148:149], v6 offset:36384
    v_mfma_f32_16x16x32_bf16 v[44:47], v[84:87], v[104:107], v[44:47]
    ds_read_b64_tr_b16 v[150:151], v6 offset:36496
    v_mfma_f32_16x16x32_bf16 v[76:79], v[88:91], v[104:107], v[76:79]
    v_mfma_f32_16x16x32_bf16 v[48:51], v[108:111], v[80:83], v[48:51]
    v_mfma_f32_16x16x32_bf16 v[56:59], v[108:111], v[84:87], v[56:59]
    v_mfma_f32_16x16x32_bf16 v[52:55], v[112:115], v[80:83], v[52:55]
    v_mfma_f32_16x16x32_bf16 v[60:63], v[112:115], v[84:87], v[60:63]
    s_waitcnt lgkmcnt(10)
    v_mfma_f32_16x16x32_bf16 v[16:19], v[128:131], v[116:119], v[16:19]
    v_mfma_f32_16x16x32_bf16 v[24:27], v[128:131], v[120:123], v[24:27]
    v_mfma_f32_16x16x32_bf16 v[64:67], v[128:131], v[124:127], v[64:67]
    s_waitcnt lgkmcnt(8)
    v_mfma_f32_16x16x32_bf16 v[20:23], v[132:135], v[116:119], v[20:23]
    v_mfma_f32_16x16x32_bf16 v[28:31], v[132:135], v[120:123], v[28:31]
    v_mfma_f32_16x16x32_bf16 v[68:71], v[132:135], v[124:127], v[68:71]
    s_waitcnt lgkmcnt(6)
    v_mfma_f32_16x16x32_bf16 v[32:35], v[116:119], v[136:139], v[32:35]
    v_mfma_f32_16x16x32_bf16 v[40:43], v[120:123], v[136:139], v[40:43]
    v_mfma_f32_16x16x32_bf16 v[72:75], v[124:127], v[136:139], v[72:75]
    s_waitcnt lgkmcnt(4)
    v_mfma_f32_16x16x32_bf16 v[36:39], v[116:119], v[140:143], v[36:39]
    v_mfma_f32_16x16x32_bf16 v[44:47], v[120:123], v[140:143], v[44:47]
    v_mfma_f32_16x16x32_bf16 v[76:79], v[124:127], v[140:143], v[76:79]
    s_waitcnt lgkmcnt(2)
    v_mfma_f32_16x16x32_bf16 v[48:51], v[144:147], v[116:119], v[48:51]
    v_mfma_f32_16x16x32_bf16 v[56:59], v[144:147], v[120:123], v[56:59]
    s_waitcnt lgkmcnt(0)
    v_mfma_f32_16x16x32_bf16 v[52:55], v[148:151], v[116:119], v[52:55]
    v_mfma_f32_16x16x32_bf16 v[60:63], v[148:151], v[120:123], v[60:63]
    v_cvt_pk_bf16_f32 v84, v16, v17
    v_cvt_pk_bf16_f32 v85, v18, v19
    v_cvt_pk_bf16_f32 v86, v20, v21
    v_cvt_pk_bf16_f32 v87, v22, v23
    v_cndmask_b32 v86, v86, 0, s[66:67]
    v_cndmask_b32 v87, v87, 0, s[66:67]
    v_cvt_pk_bf16_f32 v94, v32, v33
    v_cvt_pk_bf16_f32 v95, v34, v35
    v_mov_b32 v100, v94
    v_mov_b32 v101, v95
    v_cvt_pk_bf16_f32 v98, v36, v37
    v_cvt_pk_bf16_f32 v99, v38, v39
    v_mov_b32 v104, v98
    v_mov_b32 v105, v99
    v_cvt_pk_bf16_f32 v88, v24, v25
    v_cvt_pk_bf16_f32 v89, v26, v27
    v_cvt_pk_bf16_f32 v90, v28, v29
    v_cvt_pk_bf16_f32 v91, v30, v31
    v_cndmask_b32 v90, v90, 0, s[66:67]
    v_cndmask_b32 v91, v91, 0, s[66:67]
    v_cvt_pk_bf16_f32 v102, v40, v41
    v_cvt_pk_bf16_f32 v103, v42, v43
    v_cvt_pk_bf16_f32 v106, v44, v45
    v_cvt_pk_bf16_f32 v107, v46, v47
    s_barrier
    ds_write_b128 v10, v[88:91] offset:4096
    ds_write_b64 v11, v[102:103] offset:5120
    ds_write_b64 v11, v[106:107] offset:5632
    v_cvt_pk_bf16_f32 v80, v64, v65
    v_cvt_pk_bf16_f32 v81, v66, v67
    v_cvt_pk_bf16_f32 v82, v68, v69
    v_cvt_pk_bf16_f32 v83, v70, v71
    v_cndmask_b32 v82, v82, 0, s[66:67]
    v_cndmask_b32 v83, v83, 0, s[66:67]
    v_cvt_pk_bf16_f32 v92, v72, v73
    v_cvt_pk_bf16_f32 v93, v74, v75
    v_cvt_pk_bf16_f32 v96, v76, v77
    v_cvt_pk_bf16_f32 v97, v78, v79
    s_cmp_eq_u32 s40, 0
    s_cselect_b64 s[6:7], 0, -1
    v_mov_b32 v160, 0xf149f2ca
    v_cvt_pk_bf16_f32 v108, v48, v49
    v_cvt_pk_bf16_f32 v109, v50, v51
    v_cvt_pk_bf16_f32 v110, v52, v53
    v_cvt_pk_bf16_f32 v111, v54, v55
    v_cndmask_b32 v110, v110, 0, s[66:67]
    v_cndmask_b32 v111, v111, 0, s[66:67]
    v_cvt_pk_bf16_f32 v128, v56, v57
    v_cvt_pk_bf16_f32 v129, v58, v59
    v_cvt_pk_bf16_f32 v130, v60, v61
    v_cvt_pk_bf16_f32 v131, v62, v63
    v_cndmask_b32 v130, v130, 0, s[66:67]
    v_cndmask_b32 v131, v131, 0, s[66:67]
    s_waitcnt lgkmcnt(0)
    s_barrier
    v_mfma_f32_16x16x32_bf16 v[136:139], v[88:91], v[128:131], 0
    v_mfma_f32_16x16x32_bf16 v[116:119], v[84:87], v[108:111], 0
    v_mfma_f32_16x16x32_bf16 v[132:135], v[84:87], v[128:131], 0
    v_mfma_f32_16x16x32_bf16 v[112:115], v[80:83], v[108:111], 0
    s_nop 6
    v_cvt_pk_bf16_f32 v140, v132, v133
    v_cvt_pk_bf16_f32 v120, v112, v113
    v_cvt_pk_bf16_f32 v141, v134, v135
    v_cvt_pk_bf16_f32 v121, v114, v115
    v_cvt_pk_bf16_f32 v142, v136, v137
    v_cvt_pk_bf16_f32 v122, v116, v117
    v_cvt_pk_bf16_f32 v143, v138, v139
    v_cvt_pk_bf16_f32 v123, v118, v119
    v_lshlrev_b32 v132, 16, v140
    v_lshlrev_b32 v112, 16, v120
    v_and_b32 v133, s67, v140
    v_and_b32 v113, s67, v120
    v_lshlrev_b32 v134, 16, v141
    v_lshlrev_b32 v114, 16, v121
    v_and_b32 v135, s67, v141
    v_and_b32 v115, s67, v121
    v_lshlrev_b32 v136, 16, v142
    v_lshlrev_b32 v116, 16, v122
    v_and_b32 v137, s67, v142
    v_and_b32 v117, s67, v122
    v_lshlrev_b32 v118, 16, v123
    v_lshlrev_b32 v138, 16, v143
    v_and_b32 v119, s67, v123
    v_and_b32 v139, s67, v143
    v_mul_f32 v112, s69, v112
    v_mul_f32 v132, s69, v132
    v_mul_f32 v113, s69, v113
    v_mul_f32 v133, s69, v133
    v_mul_f32 v114, s69, v114
    v_mul_f32 v134, s69, v134
    v_mul_f32 v115, s69, v115
    v_mul_f32 v135, s69, v135
    v_mul_f32 v116, s69, v116
    v_mul_f32 v136, s69, v136
    v_mul_f32 v117, s69, v117
    v_mul_f32 v137, s69, v137
    v_mul_f32 v118, s69, v118
    v_mul_f32 v138, s69, v138
    v_mul_f32 v119, s69, v119
    v_mul_f32 v139, s69, v139
    v_cvt_pk_bf16_f32 v120, v112, v113
    v_cvt_pk_bf16_f32 v140, v132, v133
    v_cvt_pk_bf16_f32 v121, v114, v115
    v_cvt_pk_bf16_f32 v122, v116, v117
    v_cvt_pk_bf16_f32 v141, v134, v135
    v_cvt_pk_bf16_f32 v123, v118, v119
    v_cvt_pk_bf16_f32 v142, v136, v137
    v_lshlrev_b32 v112, 16, v120
    v_cvt_pk_bf16_f32 v143, v138, v139
    v_and_b32 v113, s67, v120
    v_lshlrev_b32 v132, 16, v140
    v_lshlrev_b32 v114, 16, v121
    v_and_b32 v133, s67, v140
    v_and_b32 v115, s67, v121
    v_lshlrev_b32 v134, 16, v141
    v_lshlrev_b32 v116, 16, v122
    v_and_b32 v135, s67, v141
    v_and_b32 v117, s67, v122
    v_lshlrev_b32 v136, 16, v142
    v_lshlrev_b32 v118, 16, v123
    v_and_b32 v137, s67, v142
    v_and_b32 v119, s67, v123
    v_lshlrev_b32 v138, 16, v143
    v_cndmask_b32 v112, v160, v112, s[50:51]
    v_and_b32 v139, s67, v143
    v_cndmask_b32 v113, v160, v113, s[52:53]
    v_cndmask_b32 v132, v160, v132, s[50:51]
    v_cndmask_b32 v114, v160, v114, s[54:55]
    v_cndmask_b32 v115, v160, v115, s[56:57]
    v_cndmask_b32 v133, v160, v133, s[52:53]
    v_cndmask_b32 v116, v160, v116, s[58:59]
    v_cndmask_b32 v134, v160, v134, s[54:55]
    v_cndmask_b32 v117, v160, v117, s[60:61]
    v_cndmask_b32 v135, v160, v135, s[56:57]
    v_cndmask_b32 v118, v160, v118, s[62:63]
    v_cndmask_b32 v136, v160, v136, s[58:59]
    v_cndmask_b32 v119, v160, v119, s[64:65]
    v_cndmask_b32 v137, v160, v137, s[60:61]
    v_cndmask_b32 v112, v160, v112, s[6:7]
    v_cndmask_b32 v138, v160, v138, s[62:63]
    v_cndmask_b32 v113, v160, v113, s[6:7]
    v_cndmask_b32 v139, v160, v139, s[64:65]
    v_cndmask_b32 v114, v160, v114, s[6:7]
    v_max3_f32 v153, v132, v133, v134
    v_cndmask_b32 v115, v160, v115, s[6:7]
    v_max3_f32 v153, v153, v135, v136
    v_max3_f32 v152, v112, v113, v114
    v_max3_f32 v153, v153, v137, v138
    v_max3_f32 v152, v152, v115, v116
    v_max_f32 v153, v153, v139
    v_max3_f32 v152, v152, v117, v118
    v_max_f32 v152, v152, v119
    s_nop 1
    v_permlane32_swap_b32 v152, v153
    v_max_f32 v152, v152, v153
    v_mov_b32 v156, v152
    s_nop 1
    v_permlane16_swap_b32 v152, v156
    v_max_f32 v152, v152, v156
    v_mov_b32 v153, v152
    s_nop 1
    v_permlane32_swap_b32 v152, v153
    v_mul_f32 v152, s68, v152
    v_mul_f32 v153, s68, v153
    v_fma_f32 v112, v112, s68, -v152
    v_fma_f32 v132, v132, s68, -v153
    v_fma_f32 v113, v113, s68, -v152
    v_fma_f32 v133, v133, s68, -v153
    v_fma_f32 v114, v114, s68, -v152
    v_fma_f32 v134, v134, s68, -v153
    v_fma_f32 v115, v115, s68, -v152
    v_fma_f32 v135, v135, s68, -v153
    v_fma_f32 v116, v116, s68, -v152
    v_fma_f32 v136, v136, s68, -v153
    v_fma_f32 v117, v117, s68, -v152
    v_fma_f32 v137, v137, s68, -v153
    v_fma_f32 v118, v118, s68, -v152
    v_fma_f32 v138, v138, s68, -v153
    v_fma_f32 v119, v119, s68, -v152
    v_fma_f32 v139, v139, s68, -v153
    v_exp_f32 v112, v112
    v_exp_f32 v132, v132
    v_exp_f32 v113, v113
    v_exp_f32 v133, v133
    v_exp_f32 v114, v114
    v_exp_f32 v134, v134
    v_exp_f32 v115, v115
    v_exp_f32 v135, v135
    v_exp_f32 v116, v116
    v_exp_f32 v136, v136
    v_exp_f32 v117, v117
    v_exp_f32 v137, v137
    v_exp_f32 v118, v118
    v_exp_f32 v138, v138
    v_exp_f32 v119, v119
    v_exp_f32 v139, v139
    v_add_f32 v154, v112, v113
    v_add_f32 v155, v132, v133
    v_add_f32 v154, v154, v114
    v_add_f32 v155, v155, v134
    v_add_f32 v154, v154, v115
    v_add_f32 v155, v155, v135
    v_add_f32 v154, v154, v116
    v_add_f32 v155, v155, v136
    v_add_f32 v154, v154, v117
    v_add_f32 v155, v155, v137
    v_add_f32 v154, v154, v118
    v_add_f32 v155, v155, v138
    v_add_f32 v154, v154, v119
    v_add_f32 v155, v155, v139
    s_nop 1
    v_permlane32_swap_b32 v154, v155
    v_add_f32 v154, v154, v155
    v_mov_b32 v156, v154
    s_nop 1
    v_permlane16_swap_b32 v154, v156
    v_add_f32 v154, v154, v156
    v_mov_b32 v155, v154
    s_nop 1
    v_permlane32_swap_b32 v154, v155
    v_rcp_f32 v154, v154
    v_rcp_f32 v155, v155
    v_mul_f32 v112, v112, v154
    v_mul_f32 v132, v132, v155
    v_mul_f32 v113, v113, v154
    v_mul_f32 v133, v133, v155
    v_mul_f32 v114, v114, v154
    v_mul_f32 v134, v134, v155
    v_mul_f32 v115, v115, v154
    v_mul_f32 v135, v135, v155
    v_mul_f32 v116, v116, v154
    v_mul_f32 v136, v136, v155
    v_mul_f32 v117, v117, v154
    v_mul_f32 v137, v137, v155
    v_mul_f32 v118, v118, v154
    v_mul_f32 v138, v138, v155
    v_mul_f32 v119, v119, v154
    v_mul_f32 v139, v139, v155
    v_cvt_pk_bf16_f32 v124, v112, v113
    v_cvt_pk_bf16_f32 v144, v132, v133
    v_cvt_pk_bf16_f32 v125, v114, v115
    v_cvt_pk_bf16_f32 v145, v134, v135
    v_cvt_pk_bf16_f32 v126, v116, v117
    v_cvt_pk_bf16_f32 v146, v136, v137
    v_cvt_pk_bf16_f32 v127, v118, v119
    v_cvt_pk_bf16_f32 v147, v138, v139
    s_nop 0
    v_mfma_f32_16x16x32_bf16 v[32:35], v[92:95], v[124:127], 0
    v_mfma_f32_16x16x32_bf16 v[40:43], v[100:103], v[144:147], 0
    v_mfma_f32_16x16x32_bf16 v[36:39], v[96:99], v[124:127], 0
    v_mfma_f32_16x16x32_bf16 v[44:47], v[104:107], v[144:147], 0
    s_nop 4
    v_cvt_pk_bf16_f32 v108, v32, v33
    v_cvt_pk_bf16_f32 v128, v40, v41
    v_cvt_pk_bf16_f32 v109, v34, v35
    v_cvt_pk_bf16_f32 v129, v42, v43
    v_cvt_pk_bf16_f32 v110, v36, v37
    v_cvt_pk_bf16_f32 v130, v44, v45
    v_cvt_pk_bf16_f32 v111, v38, v39
    v_cvt_pk_bf16_f32 v131, v46, v47
    v_cndmask_b32 v110, v110, 0, s[66:67]
    v_cndmask_b32 v130, v130, 0, s[66:67]
    v_cndmask_b32 v111, v111, 0, s[66:67]
    v_cndmask_b32 v131, v131, 0, s[66:67]
    v_min_u32 v108, -2, v108
    v_min_u32 v128, -2, v128
    v_min_u32 v109, -2, v109
    v_min_u32 v129, -2, v129
    v_min_u32 v110, -2, v110
    v_min_u32 v130, -2, v130
    v_min_u32 v111, -2, v111
    v_min_u32 v131, -2, v131
    buffer_store_dwordx4 v[108:111], v8, s[16:19], 0 offen sc1
    buffer_store_dwordx4 v[128:131], v8, s[16:19], s5 offen sc1
    s_barrier
    s_and_b32 s50, s43, 3
    s_lshr_b32 s51, s43, 2
    s_lshl_b32 s71, s44, 2
    s_add_u32 s71, s71, s50
    s_lshl_b32 s52, s71, 14
    s_lshl_b32 s53, s51, 13
    s_add_u32 s52, s52, s53
    v_add_u32 v4, s52, v3
    s_lshl_b32 s71, s71, 4
    v_add_u32 v5, s71, v1
    v_bfe_u32 v160, v0, 2, 2
    v_lshl_add_u32 v160, v2, 2, v160
    v_bfe_u32 v161, v160, 1, 2
    v_and_b32 v153, 3, v0
    v_lshlrev_b32 v153, 3, v153
    v_lshl_add_u32 v153, v160, 7, v153
    s_mul_i32 s71, s51, 28672
    s_add_u32 s71, s71, 58368
    v_add_u32 v153, s71, v153
    s_lshl_b32 s71, s51, 1
    v_xor_b32 v161, s71, v161
    v_xor_b32 v160, 0, v161
    v_lshl_add_u32 v12, v160, 5, v153
    v_xor_b32 v160, 1, v161
    v_lshl_add_u32 v13, v160, 5, v153
    v_xor_b32 v160, 2, v161
    v_lshl_add_u32 v14, v160, 5, v153
    v_xor_b32 v160, 3, v161
    v_lshl_add_u32 v15, v160, 5, v153
    v_add_u32 v7, 4096, v4
    v_lshlrev_b32 v9, 2, v5
    v_add_u32 v9, 5242880, v9
    s_nop 1
    s_branch L_p3
L_B_main:
    s_waitcnt lgkmcnt(0)
    s_mov_b32 s8, s72
    s_and_b32 s9, s73, 0xffff
    s_mov_b32 s10, 1835008
    s_mov_b32 s11, 0x20000
    s_cmp_eq_u32 s42, 0
    s_cselect_b32 s47, s74, s80
    s_cselect_b32 s48, s75, s81
    s_mov_b32 s12, s47
    s_and_b32 s13, s48, 0xffff
    s_mov_b32 s14, 1204224
    s_mov_b32 s15, 0x20000
    s_mov_b32 s71, 25088
    s_cmp_eq_u32 s42, 0
    s_cselect_b32 s47, s86, s82
    s_cselect_b32 s48, s87, s83
    s_cselect_b32 s71, 896, s71
    s_mov_b32 s24, s47
    s_and_b32 s25, s48, 0xffff
    s_mov_b32 s26, s71
    s_mov_b32 s27, 0x20000
    s_mov_b32 s16, s92
    s_and_b32 s17, s93, 0xffff
    s_mov_b32 s18, 16777216
    s_mov_b32 s19, 0x20000
    s_mov_b32 s28, s76
    s_and_b32 s29, s77, 0xffff
    s_mov_b32 s30, 401408
    s_mov_b32 s31, 0x20000
    s_mov_b32 s32, s84
    s_and_b32 s33, s85, 0xffff
    s_mov_b32 s34, 401408
    s_mov_b32 s35, 0x20000
    s_mov_b32 s36, s88
    s_and_b32 s37, s89, 0xffff
    s_mov_b32 s38, 1835008
    s_mov_b32 s39, 0x20000
    s_mov_b32 s20, s90
    s_and_b32 s21, s91, 0xffff
    s_mov_b32 s22, 256
    s_mov_b32 s23, 0x20000
    v_bfe_u32 v152, v0, 2, 2
    v_and_b32 v153, 3, v0
    v_lshlrev_b32 v154, 3, v2
    v_lshl_add_u32 v154, v152, 1, v154
    v_mul_u32_u24 v154, 112, v154
    v_lshl_add_u32 v6, v153, 3, v154
    s_mul_i32 s47, s4, 56
    v_add_u32 v6, s47, v6
    v_lshrrev_b32 v152, 1, v1
    v_xor_b32 v152, v152, v2
    v_lshlrev_b32 v152, 4, v152
    v_lshl_add_u32 v152, v1, 7, v152
    s_lshl_b32 s47, s3, 12
    v_add_u32 v4, s47, v152
    v_xor_b32 v5, 64, v4
    s_lshl_b32 s47, s40, 3
    s_lshl_b32 s48, s3, 1
    s_add_u32 s47, s47, s48
    s_lshl_b32 s47, s47, 4
    s_lshl_b32 s48, s41, 1
    s_add_u32 s47, s47, s48
    s_add_u32 s47, s47, s4
    s_lshl_b32 s47, s47, 10
    s_lshl_b32 s48, s42, 21
    s_add_u32 s47, s47, s48
    v_add_u32 v8, s47, v3
    s_mov_b32 s5, 16384
    s_barrier
    s_cmp_ge_u32 s43, 6
    s_cbranch_scc1 L_pfx_13
    s_cmp_lt_u32 s43, 3
    s_cselect_b32 s47, s74, s80
    s_cselect_b32 s48, s75, s81
    s_cselect_b32 s71, 0, 3
    s_mov_b32 s52, s47
    s_and_b32 s53, s48, 0xffff
    s_mov_b32 s54, 1204224
    s_mov_b32 s55, 0x20000
    s_sub_u32 s71, s43, s71
    s_lshl_b32 s71, s71, 6
    v_add_u32 v152, s71, v0
    v_mul_u32_u24 v153, 5462, v152
    v_lshrrev_b32 v153, 16, v153
    v_mul_u32_u24 v154, 12, v153
    v_sub_u32 v154, v152, v154
    v_lshrrev_b32 v155, 2, v154
    v_and_b32 v154, 3, v154
    s_mul_i32 s71, s46, 14
    v_add_u32 v153, s71, v153
    v_mul_u32_u24 v153, 2688, v153
    v_mul_u32_u24 v155, 896, v155
    v_lshl_add_u32 v154, v154, 7, v155
    s_lshr_b32 s71, s41, 2
    s_mul_i32 s71, s71, 384
    v_add3_u32 v153, v153, v154, s71
    v_mov_b32 v154, 0x1000000
    v_cmp_gt_u32 vcc, 168, v152
    s_nop 1
    v_cndmask_b32 v153, v154, v153, vcc
    buffer_load_dword v15, v153, s[52:55], 0 offen
    s_nop 0
    s_branch L_pfd_14
L_pfx_13:
    s_sub_u32 s71, s43, 6
    s_lshl_b32 s71, s71, 6
    v_add_u32 v152, s71, v0
    s_mul_i32 s71, s46, 112
    s_lshr_b32 s48, s40, 2
    s_mul_i32 s48, s48, 3584
    s_add_u32 s71, s71, s48
    v_add_u32 v153, s71, v152
    v_lshlrev_b32 v153, 7, v153
    v_mov_b32 v154, 0x1000000
    v_cmp_gt_u32 vcc, 112, v152
    s_nop 1
    v_cndmask_b32 v153, v154, v153, vcc
    s_waitcnt vmcnt(0)
    buffer_load_dword v15, v153, s[8:11], 0 offen
L_pfd_14:
    v_mov_b32 v72, -1
    v_mov_b32 v164, 0x3f803f80
    v_mov_b32 v73, -1
    v_mov_b32 v165, 0x3f803f80
    v_mov_b32 v74, -1
    v_mov_b32 v166, 0x3f803f80
    v_mov_b32 v75, -1
    v_mov_b32 v167, 0x3f803f80
    v_mov_b32 v162, s68
    v_mov_b32 v163, s68
    s_lshl_b32 s47, s41, 4
    s_add_u32 s47, s47, s40
    s_lshl_b32 s47, s47, 3
    s_add_u32 s47, s47, s43
    s_lshl_b32 s47, s47, 10
    s_add_u32 s47, s47, 4194304
    v_add_u32 v14, s47, v3
    v_mov_b32 v7, 0
    v_mov_b32 v152, 0x7149f2ca
    v_cndmask_b32 v7, v7, v152, s[66:67]
    s_lshl_b32 s71, s3, 5
    v_add_u32 v13, s71, v1
    v_mul_u32_u24 v9, 264, v13
    v_lshl_add_u32 v9, v2, 3, v9
    s_lshl_b32 s71, s4, 7
    v_add_u32 v9, s71, v9
    v_mul_u32_u24 v10, 72, v13
    v_lshl_add_u32 v10, v2, 3, v10
    s_mul_i32 s47, s4, 9216
    s_add_u32 s47, s47, 33792
    v_add_u32 v10, s47, v10
    v_and_b32 v152, 1, v2
    v_lshlrev_b32 v152, 4, v152
    v_bfe_u32 v153, v0, 2, 2
    v_lshl_add_u32 v152, v153, 2, v152
    v_lshrrev_b32 v153, 1, v2
    v_lshl_add_u32 v152, v153, 1, v152
    v_and_b32 v153, 3, v0
    v_lshlrev_b32 v153, 3, v153
    s_lshr_b32 s47, s43, 1
    s_lshl_b32 s47, s47, 6
    v_mul_u32_u24 v11, 264, v152
    v_add3_u32 v11, v11, v153, s47
    s_lshr_b32 s47, s43, 2
    s_mul_i32 s47, s47, 9216
    s_add_u32 s47, s47, 33792
    s_and_b32 s48, s43, 1
    s_lshl_b32 s48, s48, 5
    s_add_u32 s47, s47, s48
    v_mul_u32_u24 v12, 72, v152
    v_add3_u32 v12, v12, v153, s47
    v_bfe_u32 v152, v0, 2, 2
    v_lshl_add_u32 v152, v2, 2, v152
    v_mul_u32_u24 v152, 56, v152
    s_mul_i32 s71, s4, 1568
    s_add_u32 s71, s71, 159744
    v_add_u32 v152, s71, v152
    v_and_b32 v153, 3, v0
    v_min_u32 v161, 2, v153
    v_lshl_add_u32 v160, v153, 3, v152
    v_lshl_add_u32 v161, v161, 3, v152
    s_barrier
    ds_read_b128 v[88:91], v4 offset:0
    ds_read_b128 v[92:95], v4 offset:2048
    ds_read_b64_tr_b16 v[96:97], v6 offset:18432
    ds_read_b64_tr_b16 v[98:99], v6 offset:18544
    ds_read_b64_tr_b16 v[100:101], v6 offset:18464
    ds_read_b64_tr_b16 v[102:103], v6 offset:18576
    ds_read_b64_tr_b16 v[104:105], v6 offset:25600
    ds_read_b64_tr_b16 v[106:107], v6 offset:25712
    ds_read_b64_tr_b16 v[108:109], v6 offset:25632
    ds_read_b64_tr_b16 v[110:111], v6 offset:25744
    ds_read_b64_tr_b16 v[112:113], v6 offset:32768
    ds_read_b64_tr_b16 v[114:115], v6 offset:32880
    ds_read_b64_tr_b16 v[116:117], v6 offset:32800
    ds_read_b64_tr_b16 v[118:119], v6 offset:32912
    ds_read_b128 v[120:123], v5 offset:0
    s_waitcnt lgkmcnt(11)
    ds_read_b128 v[124:127], v5 offset:2048
    v_mfma_f32_16x16x32_bf16 v[16:19], v[96:99], v[88:91], 0
    ds_read_b64_tr_b16 v[128:129], v6 offset:22016
    ds_read_b64_tr_b16 v[130:131], v6 offset:22128
    v_mfma_f32_16x16x32_bf16 v[24:27], v[96:99], v[92:95], 0
    ds_read_b64_tr_b16 v[132:133], v6 offset:22048
    s_waitcnt lgkmcnt(13)
    v_mfma_f32_16x16x32_bf16 v[20:23], v[100:103], v[88:91], 0
    ds_read_b64_tr_b16 v[134:135], v6 offset:22160
    ds_read_b64_tr_b16 v[136:137], v6 offset:29184
    v_mfma_f32_16x16x32_bf16 v[28:31], v[100:103], v[92:95], 0
    s_waitcnt lgkmcnt(11)
    ds_read_b64_tr_b16 v[138:139], v6 offset:29296
    v_mfma_f32_16x16x32_bf16 v[32:35], v[104:107], v[88:91], 0
    ds_read_b64_tr_b16 v[140:141], v6 offset:29216
    ds_read_b64_tr_b16 v[142:143], v6 offset:29328
    v_mfma_f32_16x16x32_bf16 v[40:43], v[104:107], v[92:95], 0
    ds_read_b64_tr_b16 v[144:145], v6 offset:36352
    v_mfma_f32_16x16x32_bf16 v[36:39], v[108:111], v[88:91], 0
    s_waitcnt lgkmcnt(11)
    ds_read_b64_tr_b16 v[146:147], v6 offset:36464
    ds_read_b64_tr_b16 v[148:149], v6 offset:36384
    v_mfma_f32_16x16x32_bf16 v[44:47], v[108:111], v[92:95], 0
    ds_read_b64_tr_b16 v[150:151], v6 offset:36496
    v_mfma_f32_16x16x32_bf16 v[48:51], v[112:115], v[88:91], 0
    v_mfma_f32_16x16x32_bf16 v[56:59], v[112:115], v[92:95], 0
    v_mfma_f32_16x16x32_bf16 v[52:55], v[116:119], v[88:91], 0
    v_mfma_f32_16x16x32_bf16 v[60:63], v[116:119], v[92:95], 0
    s_waitcnt lgkmcnt(10)
    v_mfma_f32_16x16x32_bf16 v[16:19], v[128:131], v[120:123], v[16:19]
    v_mfma_f32_16x16x32_bf16 v[24:27], v[128:131], v[124:127], v[24:27]
    s_barrier
    v_add_u32 v4, 0x9c00, v4
    v_add_u32 v5, 0x9c00, v5
    v_add_u32 v6, 0x9c00, v6
    ds_read_b128 v[88:91], v4 offset:0
    ds_read_b128 v[92:95], v4 offset:2048
    s_waitcnt lgkmcnt(10)
    v_mfma_f32_16x16x32_bf16 v[20:23], v[132:135], v[120:123], v[20:23]
    ds_read_b64_tr_b16 v[96:97], v6 offset:18432
    ds_read_b64_tr_b16 v[98:99], v6 offset:18544
    v_mfma_f32_16x16x32_bf16 v[28:31], v[132:135], v[124:127], v[28:31]
    ds_read_b64_tr_b16 v[100:101], v6 offset:18464
    ds_read_b64_tr_b16 v[102:103], v6 offset:18576
    s_waitcnt lgkmcnt(12)
    v_mfma_f32_16x16x32_bf16 v[32:35], v[136:139], v[120:123], v[32:35]
    ds_read_b64_tr_b16 v[104:105], v6 offset:25600
    ds_read_b64_tr_b16 v[106:107], v6 offset:25712
    v_mfma_f32_16x16x32_bf16 v[40:43], v[136:139], v[124:127], v[40:43]
    ds_read_b64_tr_b16 v[108:109], v6 offset:25632
    s_waitcnt lgkmcnt(11)
    ds_read_b64_tr_b16 v[110:111], v6 offset:25744
    v_mfma_f32_16x16x32_bf16 v[36:39], v[140:143], v[120:123], v[36:39]
    ds_read_b64_tr_b16 v[112:113], v6 offset:32768
    ds_read_b64_tr_b16 v[114:115], v6 offset:32880
    v_mfma_f32_16x16x32_bf16 v[44:47], v[140:143], v[124:127], v[44:47]
    ds_read_b64_tr_b16 v[116:117], v6 offset:32800
    s_waitcnt lgkmcnt(11)
    ds_read_b64_tr_b16 v[118:119], v6 offset:32912
    v_mfma_f32_16x16x32_bf16 v[48:51], v[144:147], v[120:123], v[48:51]
    v_mfma_f32_16x16x32_bf16 v[56:59], v[144:147], v[124:127], v[56:59]
    v_mfma_f32_16x16x32_bf16 v[52:55], v[148:151], v[120:123], v[52:55]
    v_mfma_f32_16x16x32_bf16 v[60:63], v[148:151], v[124:127], v[60:63]
    ds_read_b128 v[120:123], v5 offset:0
    ds_read_b128 v[124:127], v5 offset:2048
    s_waitcnt lgkmcnt(12)
    v_mfma_f32_16x16x32_bf16 v[16:19], v[96:99], v[88:91], v[16:19]
    ds_read_b64_tr_b16 v[128:129], v6 offset:22016
    ds_read_b64_tr_b16 v[130:131], v6 offset:22128
    v_mfma_f32_16x16x32_bf16 v[24:27], v[96:99], v[92:95], v[24:27]
    ds_read_b64_tr_b16 v[132:133], v6 offset:22048
    s_waitcnt lgkmcnt(13)
    v_mfma_f32_16x16x32_bf16 v[20:23], v[100:103], v[88:91], v[20:23]
    ds_read_b64_tr_b16 v[134:135], v6 offset:22160
    ds_read_b64_tr_b16 v[136:137], v6 offset:29184
    v_mfma_f32_16x16x32_bf16 v[28:31], v[100:103], v[92:95], v[28:31]
    s_waitcnt lgkmcnt(11)
    ds_read_b64_tr_b16 v[138:139], v6 offset:29296
    v_mfma_f32_16x16x32_bf16 v[32:35], v[104:107], v[88:91], v[32:35]
    ds_read_b64_tr_b16 v[140:141], v6 offset:29216
    ds_read_b64_tr_b16 v[142:143], v6 offset:29328
    v_mfma_f32_16x16x32_bf16 v[40:43], v[104:107], v[92:95], v[40:43]
    ds_read_b64_tr_b16 v[144:145], v6 offset:36352
    v_mfma_f32_16x16x32_bf16 v[36:39], v[108:111], v[88:91], v[36:39]
    s_waitcnt lgkmcnt(11)
    ds_read_b64_tr_b16 v[146:147], v6 offset:36464
    ds_read_b64_tr_b16 v[148:149], v6 offset:36384
    v_mfma_f32_16x16x32_bf16 v[44:47], v[108:111], v[92:95], v[44:47]
    ds_read_b64_tr_b16 v[150:151], v6 offset:36496
    v_mfma_f32_16x16x32_bf16 v[48:51], v[112:115], v[88:91], v[48:51]
    v_mfma_f32_16x16x32_bf16 v[56:59], v[112:115], v[92:95], v[56:59]
    v_mfma_f32_16x16x32_bf16 v[52:55], v[116:119], v[88:91], v[52:55]
    v_mfma_f32_16x16x32_bf16 v[60:63], v[116:119], v[92:95], v[60:63]
    s_waitcnt lgkmcnt(10)
    v_mfma_f32_16x16x32_bf16 v[16:19], v[128:131], v[120:123], v[16:19]
    v_mfma_f32_16x16x32_bf16 v[24:27], v[128:131], v[124:127], v[24:27]
    s_barrier
    v_add_u32 v4, 0x9c00, v4
    v_add_u32 v5, 0x9c00, v5
    v_add_u32 v6, 0x9c00, v6
    ds_read_b128 v[88:91], v4 offset:0
    ds_read_b128 v[92:95], v4 offset:2048
    s_waitcnt lgkmcnt(10)
    v_mfma_f32_16x16x32_bf16 v[20:23], v[132:135], v[120:123], v[20:23]
    ds_read_b64_tr_b16 v[96:97], v6 offset:18432
    ds_read_b64_tr_b16 v[98:99], v6 offset:18544
    v_mfma_f32_16x16x32_bf16 v[28:31], v[132:135], v[124:127], v[28:31]
    ds_read_b64_tr_b16 v[100:101], v6 offset:18464
    ds_read_b64_tr_b16 v[102:103], v6 offset:18576
    s_waitcnt lgkmcnt(12)
    v_mfma_f32_16x16x32_bf16 v[32:35], v[136:139], v[120:123], v[32:35]
    ds_read_b64_tr_b16 v[104:105], v6 offset:25600
    ds_read_b64_tr_b16 v[106:107], v6 offset:25712
    v_mfma_f32_16x16x32_bf16 v[40:43], v[136:139], v[124:127], v[40:43]
    ds_read_b64_tr_b16 v[108:109], v6 offset:25632
    s_waitcnt lgkmcnt(11)
    ds_read_b64_tr_b16 v[110:111], v6 offset:25744
    v_mfma_f32_16x16x32_bf16 v[36:39], v[140:143], v[120:123], v[36:39]
    ds_read_b64_tr_b16 v[112:113], v6 offset:32768
    ds_read_b64_tr_b16 v[114:115], v6 offset:32880
    v_mfma_f32_16x16x32_bf16 v[44:47], v[140:143], v[124:127], v[44:47]
    ds_read_b64_tr_b16 v[116:117], v6 offset:32800
    s_waitcnt lgkmcnt(11)
    ds_read_b64_tr_b16 v[118:119], v6 offset:32912
    v_mfma_f32_16x16x32_bf16 v[48:51], v[144:147], v[120:123], v[48:51]
    v_mfma_f32_16x16x32_bf16 v[56:59], v[144:147], v[124:127], v[56:59]
    v_mfma_f32_16x16x32_bf16 v[52:55], v[148:151], v[120:123], v[52:55]
    v_mfma_f32_16x16x32_bf16 v[60:63], v[148:151], v[124:127], v[60:63]
    ds_read_b128 v[120:123], v5 offset:0
    ds_read_b128 v[124:127], v5 offset:2048
    s_waitcnt lgkmcnt(12)
    v_mfma_f32_16x16x32_bf16 v[16:19], v[96:99], v[88:91], v[16:19]
    ds_read_b64_tr_b16 v[128:129], v6 offset:22016
    ds_read_b64_tr_b16 v[130:131], v6 offset:22128
    v_mfma_f32_16x16x32_bf16 v[24:27], v[96:99], v[92:95], v[24:27]
    ds_read_b64_tr_b16 v[132:133], v6 offset:22048
    s_waitcnt lgkmcnt(13)
    v_mfma_f32_16x16x32_bf16 v[20:23], v[100:103], v[88:91], v[20:23]
    ds_read_b64_tr_b16 v[134:135], v6 offset:22160
    ds_read_b64_tr_b16 v[136:137], v6 offset:29184
    v_mfma_f32_16x16x32_bf16 v[28:31], v[100:103], v[92:95], v[28:31]
    s_waitcnt lgkmcnt(11)
    ds_read_b64_tr_b16 v[138:139], v6 offset:29296
    v_mfma_f32_16x16x32_bf16 v[32:35], v[104:107], v[88:91], v[32:35]
    ds_read_b64_tr_b16 v[140:141], v6 offset:29216
    ds_read_b64_tr_b16 v[142:143], v6 offset:29328
    v_mfma_f32_16x16x32_bf16 v[40:43], v[104:107], v[92:95], v[40:43]
    ds_read_b64_tr_b16 v[144:145], v6 offset:36352
    v_mfma_f32_16x16x32_bf16 v[36:39], v[108:111], v[88:91], v[36:39]
    s_waitcnt lgkmcnt(11)
    ds_read_b64_tr_b16 v[146:147], v6 offset:36464
    ds_read_b64_tr_b16 v[148:149], v6 offset:36384
    v_mfma_f32_16x16x32_bf16 v[44:47], v[108:111], v[92:95], v[44:47]
    ds_read_b64_tr_b16 v[150:151], v6 offset:36496
    v_mfma_f32_16x16x32_bf16 v[48:51], v[112:115], v[88:91], v[48:51]
    v_mfma_f32_16x16x32_bf16 v[56:59], v[112:115], v[92:95], v[56:59]
    v_mfma_f32_16x16x32_bf16 v[52:55], v[116:119], v[88:91], v[52:55]
    v_mfma_f32_16x16x32_bf16 v[60:63], v[116:119], v[92:95], v[60:63]
    s_waitcnt lgkmcnt(10)
    v_mfma_f32_16x16x32_bf16 v[16:19], v[128:131], v[120:123], v[16:19]
    v_mfma_f32_16x16x32_bf16 v[24:27], v[128:131], v[124:127], v[24:27]
    ds_read_b64_tr_b16 v[64:65], v160 offset:0
    ds_read_b64_tr_b16 v[66:67], v160 offset:896
    ds_read_b64_tr_b16 v[68:69], v161 offset:32
    ds_read_b64_tr_b16 v[70:71], v161 offset:928
    s_waitcnt lgkmcnt(2)
    v_cndmask_b32 v66, v66, 0, s[66:67]
    v_cndmask_b32 v67, v67, 0, s[66:67]
    s_waitcnt lgkmcnt(0)
    v_cndmask_b32 v70, v70, 0, s[66:67]
    v_cndmask_b32 v71, v71, 0, s[66:67]
    s_barrier
    v_add_u32 v4, 0x9c00, v4
    v_add_u32 v5, 0x9c00, v5
    v_add_u32 v6, 0x9c00, v6
    ds_read_b128 v[88:91], v4 offset:0
    ds_read_b128 v[92:95], v4 offset:2048
    v_mfma_f32_16x16x32_bf16 v[20:23], v[132:135], v[120:123], v[20:23]
    ds_read_b64_tr_b16 v[96:97], v6 offset:18432
    ds_read_b64_tr_b16 v[98:99], v6 offset:18544
    v_mfma_f32_16x16x32_bf16 v[28:31], v[132:135], v[124:127], v[28:31]
    ds_read_b64_tr_b16 v[100:101], v6 offset:18464
    ds_read_b64_tr_b16 v[102:103], v6 offset:18576
    v_mfma_f32_16x16x32_bf16 v[32:35], v[136:139], v[120:123], v[32:35]
    ds_read_b64_tr_b16 v[104:105], v6 offset:25600
    ds_read_b64_tr_b16 v[106:107], v6 offset:25712
    v_mfma_f32_16x16x32_bf16 v[40:43], v[136:139], v[124:127], v[40:43]
    ds_read_b64_tr_b16 v[108:109], v6 offset:25632
    ds_read_b64_tr_b16 v[110:111], v6 offset:25744
    v_mfma_f32_16x16x32_bf16 v[36:39], v[140:143], v[120:123], v[36:39]
    ds_read_b64_tr_b16 v[112:113], v6 offset:32768
    ds_read_b64_tr_b16 v[114:115], v6 offset:32880
    v_mfma_f32_16x16x32_bf16 v[44:47], v[140:143], v[124:127], v[44:47]
    ds_read_b64_tr_b16 v[116:117], v6 offset:32800
    ds_read_b64_tr_b16 v[118:119], v6 offset:32912
    v_mfma_f32_16x16x32_bf16 v[48:51], v[144:147], v[120:123], v[48:51]
    v_mfma_f32_16x16x32_bf16 v[56:59], v[144:147], v[124:127], v[56:59]
    v_mfma_f32_16x16x32_bf16 v[52:55], v[148:151], v[120:123], v[52:55]
    v_mfma_f32_16x16x32_bf16 v[60:63], v[148:151], v[124:127], v[60:63]
    ds_read_b128 v[120:123], v5 offset:0
    s_waitcnt lgkmcnt(11)
    ds_read_b128 v[124:127], v5 offset:2048
    v_mfma_f32_16x16x32_bf16 v[16:19], v[96:99], v[88:91], v[16:19]
    ds_read_b64_tr_b16 v[128:129], v6 offset:22016
    ds_read_b64_tr_b16 v[130:131], v6 offset:22128
    v_mfma_f32_16x16x32_bf16 v[24:27], v[96:99], v[92:95], v[24:27]
    ds_read_b64_tr_b16 v[132:133], v6 offset:22048
    s_waitcnt lgkmcnt(13)
    v_mfma_f32_16x16x32_bf16 v[20:23], v[100:103], v[88:91], v[20:23]
    ds_read_b64_tr_b16 v[134:135], v6 offset:22160
    ds_read_b64_tr_b16 v[136:137], v6 offset:29184
    v_mfma_f32_16x16x32_bf16 v[28:31], v[100:103], v[92:95], v[28:31]
    s_waitcnt lgkmcnt(11)
    ds_read_b64_tr_b16 v[138:139], v6 offset:29296
    v_mfma_f32_16x16x32_bf16 v[32:35], v[104:107], v[88:91], v[32:35]
    ds_read_b64_tr_b16 v[140:141], v6 offset:29216
    ds_read_b64_tr_b16 v[142:143], v6 offset:29328
    v_mfma_f32_16x16x32_bf16 v[40:43], v[104:107], v[92:95], v[40:43]
    ds_read_b64_tr_b16 v[144:145], v6 offset:36352
    v_mfma_f32_16x16x32_bf16 v[36:39], v[108:111], v[88:91], v[36:39]
    s_waitcnt lgkmcnt(11)
    ds_read_b64_tr_b16 v[146:147], v6 offset:36464
    ds_read_b64_tr_b16 v[148:149], v6 offset:36384
    v_mfma_f32_16x16x32_bf16 v[44:47], v[108:111], v[92:95], v[44:47]
    ds_read_b64_tr_b16 v[150:151], v6 offset:36496
    v_mfma_f32_16x16x32_bf16 v[48:51], v[112:115], v[88:91], v[48:51]
    v_mfma_f32_16x16x32_bf16 v[56:59], v[112:115], v[92:95], v[56:59]
    v_mfma_f32_16x16x32_bf16 v[52:55], v[116:119], v[88:91], v[52:55]
    v_mfma_f32_16x16x32_bf16 v[60:63], v[116:119], v[92:95], v[60:63]
    s_waitcnt lgkmcnt(10)
    v_mfma_f32_16x16x32_bf16 v[16:19], v[128:131], v[120:123], v[16:19]
    v_mfma_f32_16x16x32_bf16 v[24:27], v[128:131], v[124:127], v[24:27]
    s_barrier
    v_add_u32 v4, 0xfffe2c00, v4
    v_add_u32 v5, 0xfffe2c00, v5
    v_add_u32 v6, 0xfffe2c00, v6
    ds_read_b128 v[88:91], v4 offset:0
    ds_read_b128 v[92:95], v4 offset:2048
    s_waitcnt lgkmcnt(10)
    v_mfma_f32_16x16x32_bf16 v[20:23], v[132:135], v[120:123], v[20:23]
    ds_read_b64_tr_b16 v[96:97], v6 offset:18432
    ds_read_b64_tr_b16 v[98:99], v6 offset:18544
    v_mfma_f32_16x16x32_bf16 v[28:31], v[132:135], v[124:127], v[28:31]
    ds_read_b64_tr_b16 v[100:101], v6 offset:18464
    ds_read_b64_tr_b16 v[102:103], v6 offset:18576
    s_waitcnt lgkmcnt(12)
    v_mfma_f32_16x16x32_bf16 v[32:35], v[136:139], v[120:123], v[32:35]
    ds_read_b64_tr_b16 v[104:105], v6 offset:25600
    ds_read_b64_tr_b16 v[106:107], v6 offset:25712
    v_mfma_f32_16x16x32_bf16 v[40:43], v[136:139], v[124:127], v[40:43]
    ds_read_b64_tr_b16 v[108:109], v6 offset:25632
    s_waitcnt lgkmcnt(11)
    ds_read_b64_tr_b16 v[110:111], v6 offset:25744
    v_mfma_f32_16x16x32_bf16 v[36:39], v[140:143], v[120:123], v[36:39]
    ds_read_b64_tr_b16 v[112:113], v6 offset:32768
    ds_read_b64_tr_b16 v[114:115], v6 offset:32880
    v_mfma_f32_16x16x32_bf16 v[44:47], v[140:143], v[124:127], v[44:47]
    ds_read_b64_tr_b16 v[116:117], v6 offset:32800
    s_waitcnt lgkmcnt(11)
    ds_read_b64_tr_b16 v[118:119], v6 offset:32912
    v_mfma_f32_16x16x32_bf16 v[48:51], v[144:147], v[120:123], v[48:51]
    v_mfma_f32_16x16x32_bf16 v[56:59], v[144:147], v[124:127], v[56:59]
    v_mfma_f32_16x16x32_bf16 v[52:55], v[148:151], v[120:123], v[52:55]
    v_mfma_f32_16x16x32_bf16 v[60:63], v[148:151], v[124:127], v[60:63]
    ds_read_b128 v[120:123], v5 offset:0
    ds_read_b128 v[124:127], v5 offset:2048
    s_waitcnt lgkmcnt(12)
    v_mfma_f32_16x16x32_bf16 v[16:19], v[96:99], v[88:91], v[16:19]
    ds_read_b64_tr_b16 v[128:129], v6 offset:22016
    ds_read_b64_tr_b16 v[130:131], v6 offset:22128
    v_mfma_f32_16x16x32_bf16 v[24:27], v[96:99], v[92:95], v[24:27]
    ds_read_b64_tr_b16 v[132:133], v6 offset:22048
    s_waitcnt lgkmcnt(13)
    v_mfma_f32_16x16x32_bf16 v[20:23], v[100:103], v[88:91], v[20:23]
    ds_read_b64_tr_b16 v[134:135], v6 offset:22160
    ds_read_b64_tr_b16 v[136:137], v6 offset:29184
    v_mfma_f32_16x16x32_bf16 v[28:31], v[100:103], v[92:95], v[28:31]
    s_waitcnt lgkmcnt(11)
    ds_read_b64_tr_b16 v[138:139], v6 offset:29296
    v_mfma_f32_16x16x32_bf16 v[32:35], v[104:107], v[88:91], v[32:35]
    ds_read_b64_tr_b16 v[140:141], v6 offset:29216
    ds_read_b64_tr_b16 v[142:143], v6 offset:29328
    v_mfma_f32_16x16x32_bf16 v[40:43], v[104:107], v[92:95], v[40:43]
    ds_read_b64_tr_b16 v[144:145], v6 offset:36352
    v_mfma_f32_16x16x32_bf16 v[36:39], v[108:111], v[88:91], v[36:39]
    s_waitcnt lgkmcnt(11)
    ds_read_b64_tr_b16 v[146:147], v6 offset:36464
    ds_read_b64_tr_b16 v[148:149], v6 offset:36384
    v_mfma_f32_16x16x32_bf16 v[44:47], v[108:111], v[92:95], v[44:47]
    ds_read_b64_tr_b16 v[150:151], v6 offset:36496
    v_mfma_f32_16x16x32_bf16 v[48:51], v[112:115], v[88:91], v[48:51]
    v_mfma_f32_16x16x32_bf16 v[56:59], v[112:115], v[92:95], v[56:59]
    v_mfma_f32_16x16x32_bf16 v[52:55], v[116:119], v[88:91], v[52:55]
    v_mfma_f32_16x16x32_bf16 v[60:63], v[116:119], v[92:95], v[60:63]
    s_waitcnt lgkmcnt(10)
    v_mfma_f32_16x16x32_bf16 v[16:19], v[128:131], v[120:123], v[16:19]
    v_mfma_f32_16x16x32_bf16 v[24:27], v[128:131], v[124:127], v[24:27]
    s_barrier
    v_add_u32 v4, 0x9c00, v4
    v_add_u32 v5, 0x9c00, v5
    v_add_u32 v6, 0x9c00, v6
    ds_read_b128 v[88:91], v4 offset:0
    ds_read_b128 v[92:95], v4 offset:2048
    s_waitcnt lgkmcnt(10)
    v_mfma_f32_16x16x32_bf16 v[20:23], v[132:135], v[120:123], v[20:23]
    ds_read_b64_tr_b16 v[96:97], v6 offset:18432
    ds_read_b64_tr_b16 v[98:99], v6 offset:18544
    v_mfma_f32_16x16x32_bf16 v[28:31], v[132:135], v[124:127], v[28:31]
    ds_read_b64_tr_b16 v[100:101], v6 offset:18464
    ds_read_b64_tr_b16 v[102:103], v6 offset:18576
    s_waitcnt lgkmcnt(12)
    v_mfma_f32_16x16x32_bf16 v[32:35], v[136:139], v[120:123], v[32:35]
    ds_read_b64_tr_b16 v[104:105], v6 offset:25600
    ds_read_b64_tr_b16 v[106:107], v6 offset:25712
    v_mfma_f32_16x16x32_bf16 v[40:43], v[136:139], v[124:127], v[40:43]
    ds_read_b64_tr_b16 v[108:109], v6 offset:25632
    s_waitcnt lgkmcnt(11)
    ds_read_b64_tr_b16 v[110:111], v6 offset:25744
    v_mfma_f32_16x16x32_bf16 v[36:39], v[140:143], v[120:123], v[36:39]
    ds_read_b64_tr_b16 v[112:113], v6 offset:32768
    ds_read_b64_tr_b16 v[114:115], v6 offset:32880
    v_mfma_f32_16x16x32_bf16 v[44:47], v[140:143], v[124:127], v[44:47]
    ds_read_b64_tr_b16 v[116:117], v6 offset:32800
    s_waitcnt lgkmcnt(11)
    ds_read_b64_tr_b16 v[118:119], v6 offset:32912
    v_mfma_f32_16x16x32_bf16 v[48:51], v[144:147], v[120:123], v[48:51]
    v_mfma_f32_16x16x32_bf16 v[56:59], v[144:147], v[124:127], v[56:59]
    v_mfma_f32_16x16x32_bf16 v[52:55], v[148:151], v[120:123], v[52:55]
    v_mfma_f32_16x16x32_bf16 v[60:63], v[148:151], v[124:127], v[60:63]
    ds_read_b128 v[120:123], v5 offset:0
    ds_read_b128 v[124:127], v5 offset:2048
    s_waitcnt lgkmcnt(12)
    v_mfma_f32_16x16x32_bf16 v[16:19], v[96:99], v[88:91], v[16:19]
    ds_read_b64_tr_b16 v[128:129], v6 offset:22016
    ds_read_b64_tr_b16 v[130:131], v6 offset:22128
    v_mfma_f32_16x16x32_bf16 v[24:27], v[96:99], v[92:95], v[24:27]
    ds_read_b64_tr_b16 v[132:133], v6 offset:22048
    s_waitcnt lgkmcnt(13)
    v_mfma_f32_16x16x32_bf16 v[20:23], v[100:103], v[88:91], v[20:23]
    ds_read_b64_tr_b16 v[134:135], v6 offset:22160
    ds_read_b64_tr_b16 v[136:137], v6 offset:29184
    v_mfma_f32_16x16x32_bf16 v[28:31], v[100:103], v[92:95], v[28:31]
    s_waitcnt lgkmcnt(11)
    ds_read_b64_tr_b16 v[138:139], v6 offset:29296
    v_mfma_f32_16x16x32_bf16 v[32:35], v[104:107], v[88:91], v[32:35]
    ds_read_b64_tr_b16 v[140:141], v6 offset:29216
    ds_read_b64_tr_b16 v[142:143], v6 offset:29328
    v_mfma_f32_16x16x32_bf16 v[40:43], v[104:107], v[92:95], v[40:43]
    ds_read_b64_tr_b16 v[144:145], v6 offset:36352
    v_mfma_f32_16x16x32_bf16 v[36:39], v[108:111], v[88:91], v[36:39]
    s_waitcnt lgkmcnt(11)
    ds_read_b64_tr_b16 v[146:147], v6 offset:36464
    ds_read_b64_tr_b16 v[148:149], v6 offset:36384
    v_mfma_f32_16x16x32_bf16 v[44:47], v[108:111], v[92:95], v[44:47]
    ds_read_b64_tr_b16 v[150:151], v6 offset:36496
    v_mfma_f32_16x16x32_bf16 v[48:51], v[112:115], v[88:91], v[48:51]
    v_mfma_f32_16x16x32_bf16 v[56:59], v[112:115], v[92:95], v[56:59]
    v_mfma_f32_16x16x32_bf16 v[52:55], v[116:119], v[88:91], v[52:55]
    v_mfma_f32_16x16x32_bf16 v[60:63], v[116:119], v[92:95], v[60:63]
    s_waitcnt lgkmcnt(10)
    v_mfma_f32_16x16x32_bf16 v[16:19], v[128:131], v[120:123], v[16:19]
    v_mfma_f32_16x16x32_bf16 v[24:27], v[128:131], v[124:127], v[24:27]
    s_barrier
    v_add_u32 v4, 0x9c00, v4
    v_add_u32 v5, 0x9c00, v5
    v_add_u32 v6, 0x9c00, v6
    ds_read_b128 v[88:91], v4 offset:0
    ds_read_b128 v[92:95], v4 offset:2048
    s_waitcnt lgkmcnt(10)
    v_mfma_f32_16x16x32_bf16 v[20:23], v[132:135], v[120:123], v[20:23]
    ds_read_b64_tr_b16 v[96:97], v6 offset:18432
    ds_read_b64_tr_b16 v[98:99], v6 offset:18544
    v_mfma_f32_16x16x32_bf16 v[28:31], v[132:135], v[124:127], v[28:31]
    ds_read_b64_tr_b16 v[100:101], v6 offset:18464
    ds_read_b64_tr_b16 v[102:103], v6 offset:18576
    s_waitcnt lgkmcnt(12)
    v_mfma_f32_16x16x32_bf16 v[32:35], v[136:139], v[120:123], v[32:35]
    ds_read_b64_tr_b16 v[104:105], v6 offset:25600
    ds_read_b64_tr_b16 v[106:107], v6 offset:25712
    v_mfma_f32_16x16x32_bf16 v[40:43], v[136:139], v[124:127], v[40:43]
    ds_read_b64_tr_b16 v[108:109], v6 offset:25632
    s_waitcnt lgkmcnt(11)
    ds_read_b64_tr_b16 v[110:111], v6 offset:25744
    v_mfma_f32_16x16x32_bf16 v[36:39], v[140:143], v[120:123], v[36:39]
    ds_read_b64_tr_b16 v[112:113], v6 offset:32768
    ds_read_b64_tr_b16 v[114:115], v6 offset:32880
    v_mfma_f32_16x16x32_bf16 v[44:47], v[140:143], v[124:127], v[44:47]
    ds_read_b64_tr_b16 v[116:117], v6 offset:32800
    s_waitcnt lgkmcnt(11)
    ds_read_b64_tr_b16 v[118:119], v6 offset:32912
    v_mfma_f32_16x16x32_bf16 v[48:51], v[144:147], v[120:123], v[48:51]
    v_mfma_f32_16x16x32_bf16 v[56:59], v[144:147], v[124:127], v[56:59]
    v_mfma_f32_16x16x32_bf16 v[52:55], v[148:151], v[120:123], v[52:55]
    v_mfma_f32_16x16x32_bf16 v[60:63], v[148:151], v[124:127], v[60:63]
    ds_read_b128 v[120:123], v5 offset:0
    ds_read_b128 v[124:127], v5 offset:2048
    s_waitcnt lgkmcnt(12)
    v_mfma_f32_16x16x32_bf16 v[16:19], v[96:99], v[88:91], v[16:19]
    ds_read_b64_tr_b16 v[128:129], v6 offset:22016
    ds_read_b64_tr_b16 v[130:131], v6 offset:22128
    v_mfma_f32_16x16x32_bf16 v[24:27], v[96:99], v[92:95], v[24:27]
    ds_read_b64_tr_b16 v[132:133], v6 offset:22048
    s_waitcnt lgkmcnt(13)
    v_mfma_f32_16x16x32_bf16 v[20:23], v[100:103], v[88:91], v[20:23]
    ds_read_b64_tr_b16 v[134:135], v6 offset:22160
    ds_read_b64_tr_b16 v[136:137], v6 offset:29184
    v_mfma_f32_16x16x32_bf16 v[28:31], v[100:103], v[92:95], v[28:31]
    s_waitcnt lgkmcnt(11)
    ds_read_b64_tr_b16 v[138:139], v6 offset:29296
    v_mfma_f32_16x16x32_bf16 v[32:35], v[104:107], v[88:91], v[32:35]
    ds_read_b64_tr_b16 v[140:141], v6 offset:29216
    ds_read_b64_tr_b16 v[142:143], v6 offset:29328
    v_mfma_f32_16x16x32_bf16 v[40:43], v[104:107], v[92:95], v[40:43]
    ds_read_b64_tr_b16 v[144:145], v6 offset:36352
    v_mfma_f32_16x16x32_bf16 v[36:39], v[108:111], v[88:91], v[36:39]
    s_waitcnt lgkmcnt(11)
    ds_read_b64_tr_b16 v[146:147], v6 offset:36464
    ds_read_b64_tr_b16 v[148:149], v6 offset:36384
    v_mfma_f32_16x16x32_bf16 v[44:47], v[108:111], v[92:95], v[44:47]
    ds_read_b64_tr_b16 v[150:151], v6 offset:36496
    v_mfma_f32_16x16x32_bf16 v[48:51], v[112:115], v[88:91], v[48:51]
    v_mfma_f32_16x16x32_bf16 v[56:59], v[112:115], v[92:95], v[56:59]
    v_mfma_f32_16x16x32_bf16 v[52:55], v[116:119], v[88:91], v[52:55]
    v_mfma_f32_16x16x32_bf16 v[60:63], v[116:119], v[92:95], v[60:63]
    s_waitcnt lgkmcnt(10)
    v_mfma_f32_16x16x32_bf16 v[16:19], v[128:131], v[120:123], v[16:19]
    v_mfma_f32_16x16x32_bf16 v[24:27], v[128:131], v[124:127], v[24:27]
    s_waitcnt lgkmcnt(8)
    v_mfma_f32_16x16x32_bf16 v[20:23], v[132:135], v[120:123], v[20:23]
    v_mfma_f32_16x16x32_bf16 v[28:31], v[132:135], v[124:127], v[28:31]
    s_waitcnt lgkmcnt(6)
    v_mfma_f32_16x16x32_bf16 v[32:35], v[136:139], v[120:123], v[32:35]
    v_mfma_f32_16x16x32_bf16 v[40:43], v[136:139], v[124:127], v[40:43]
    s_waitcnt lgkmcnt(4)
    v_mfma_f32_16x16x32_bf16 v[36:39], v[140:143], v[120:123], v[36:39]
    v_mfma_f32_16x16x32_bf16 v[44:47], v[140:143], v[124:127], v[44:47]
    s_waitcnt lgkmcnt(2)
    v_mfma_f32_16x16x32_bf16 v[48:51], v[144:147], v[120:123], v[48:51]
    v_mfma_f32_16x16x32_bf16 v[56:59], v[144:147], v[124:127], v[56:59]
    s_waitcnt lgkmcnt(0)
    v_mfma_f32_16x16x32_bf16 v[52:55], v[148:151], v[120:123], v[52:55]
    v_mfma_f32_16x16x32_bf16 v[60:63], v[148:151], v[124:127], v[60:63]
    v_cvt_pk_bf16_f32 v120, v16, v17
    v_cvt_pk_bf16_f32 v136, v24, v25
    v_cvt_pk_bf16_f32 v121, v18, v19
    v_cvt_pk_bf16_f32 v137, v26, v27
    v_cvt_pk_bf16_f32 v122, v20, v21
    v_cvt_pk_bf16_f32 v138, v28, v29
    v_cvt_pk_bf16_f32 v123, v22, v23
    v_cvt_pk_bf16_f32 v139, v30, v31
    v_cndmask_b32 v122, v122, 0, s[66:67]
    v_cndmask_b32 v138, v138, 0, s[66:67]
    v_cndmask_b32 v123, v123, 0, s[66:67]
    v_cndmask_b32 v139, v139, 0, s[66:67]
    s_nop 0
    v_mfma_f32_16x16x32_bf16 v[16:19], v[64:67], v[120:123], 0
    v_mfma_f32_16x16x32_bf16 v[24:27], v[64:67], v[136:139], 0
    v_mfma_f32_16x16x32_bf16 v[20:23], v[68:71], v[120:123], 0
    v_mfma_f32_16x16x32_bf16 v[28:31], v[68:71], v[136:139], 0
    v_mov_b32 v160, 0x3f80
    v_cvt_pk_bf16_f32 v152, v32, v33
    v_cvt_pk_bf16_f32 v153, v34, v35
    v_cvt_pk_bf16_f32 v154, v36, v37
    v_cvt_pk_bf16_f32 v155, v38, v39
    v_cndmask_b32 v154, v154, v160, s[66:67]
    v_cndmask_b32 v155, v155, 0, s[66:67]
    v_cvt_pk_bf16_f32 v156, v40, v41
    v_cvt_pk_bf16_f32 v157, v42, v43
    v_cvt_pk_bf16_f32 v158, v44, v45
    v_cvt_pk_bf16_f32 v159, v46, v47
    v_cndmask_b32 v158, v158, v160, s[66:67]
    v_cndmask_b32 v159, v159, 0, s[66:67]
    ds_write_b64 v10, v[152:153] offset:0
    ds_write_b64 v10, v[154:155] offset:32
    ds_write_b64 v10, v[156:157] offset:1152
    ds_write_b64 v10, v[158:159] offset:1184
    v_cvt_pk_bf16_f32 v120, v16, v17
    v_cvt_pk_bf16_f32 v136, v24, v25
    v_cvt_pk_bf16_f32 v121, v18, v19
    v_cvt_pk_bf16_f32 v137, v26, v27
    v_cvt_pk_bf16_f32 v122, v20, v21
    v_cvt_pk_bf16_f32 v138, v28, v29
    v_cvt_pk_bf16_f32 v123, v22, v23
    v_cvt_pk_bf16_f32 v139, v30, v31
    v_lshlrev_b32 v16, 16, v120
    v_lshlrev_b32 v24, 16, v136
    v_and_b32 v17, s67, v120
    v_and_b32 v25, s67, v136
    v_lshlrev_b32 v18, 16, v121
    v_lshlrev_b32 v26, 16, v137
    v_and_b32 v19, s67, v121
    v_and_b32 v27, s67, v137
    v_lshlrev_b32 v20, 16, v122
    v_lshlrev_b32 v28, 16, v138
    v_and_b32 v21, s67, v122
    v_and_b32 v29, s67, v138
    v_lshlrev_b32 v22, 16, v123
    v_lshlrev_b32 v30, 16, v139
    v_and_b32 v23, s67, v123
    v_and_b32 v31, s67, v139
    v_max3_f32 v132, v16, v17, v18
    v_max3_f32 v148, v24, v25, v26
    v_min3_f32 v133, v16, v17, v18
    v_min3_f32 v149, v24, v25, v26
    v_max3_f32 v132, v132, v19, v20
    v_max3_f32 v148, v148, v27, v28
    v_min3_f32 v133, v133, v19, v20
    v_min3_f32 v149, v149, v27, v28
    v_max3_f32 v132, v132, v21, v22
    v_max3_f32 v148, v148, v29, v30
    v_min3_f32 v133, v133, v21, v22
    v_min3_f32 v149, v149, v29, v30
    v_max_f32 v132, v132, v23
    v_max_f32 v148, v148, v31
    v_max_f32 v133, -v133, -v23
    v_max_f32 v149, -v149, -v31
    s_nop 0
    v_permlane32_swap_b32 v132, v133
    v_permlane32_swap_b32 v148, v149
    v_max_f32 v132, v132, v133
    v_max_f32 v148, v148, v149
    v_mov_b32 v120, v132
    v_mov_b32 v136, v148
    s_nop 0
    v_permlane16_swap_b32 v132, v120
    v_permlane16_swap_b32 v148, v136
    v_max_f32 v132, v132, v120
    v_max_f32 v148, v148, v136
    v_mov_b32 v133, v132
    v_mov_b32 v149, v148
    s_nop 0
    v_permlane32_swap_b32 v132, v133
    v_permlane32_swap_b32 v148, v149
    v_mul_f32 v132, s68, v132
    v_mul_f32 v148, s68, v148
    v_mul_f32 v133, s68, v133
    v_mul_f32 v149, s68, v149
    v_add_f32 v134, v132, v7
    v_add_f32 v150, v148, v7
    v_add_f32 v135, v133, v7
    v_add_f32 v151, v149, v7
    v_pk_fma_f32 v[124:125], v[16:17], v[162:163], v[132:133] op_sel:[0,0,1] op_sel_hi:[1,1,1] neg_lo:[1,0,1] neg_hi:[1,0,1]
    v_pk_fma_f32 v[140:141], v[24:25], v[162:163], v[148:149] op_sel:[0,0,1] op_sel_hi:[1,1,1] neg_lo:[1,0,1] neg_hi:[1,0,1]
    v_pk_fma_f32 v[16:17], v[16:17], v[162:163], v[132:133] op_sel_hi:[1,1,0] neg_lo:[0,0,1] neg_hi:[0,0,1]
    v_pk_fma_f32 v[24:25], v[24:25], v[162:163], v[148:149] op_sel_hi:[1,1,0] neg_lo:[0,0,1] neg_hi:[0,0,1]
    v_pk_fma_f32 v[126:127], v[18:19], v[162:163], v[132:133] op_sel:[0,0,1] op_sel_hi:[1,1,1] neg_lo:[1,0,1] neg_hi:[1,0,1]
    v_pk_fma_f32 v[142:143], v[26:27], v[162:163], v[148:149] op_sel:[0,0,1] op_sel_hi:[1,1,1] neg_lo:[1,0,1] neg_hi:[1,0,1]
    v_pk_fma_f32 v[18:19], v[18:19], v[162:163], v[132:133] op_sel_hi:[1,1,0] neg_lo:[0,0,1] neg_hi:[0,0,1]
    v_pk_fma_f32 v[26:27], v[26:27], v[162:163], v[148:149] op_sel_hi:[1,1,0] neg_lo:[0,0,1] neg_hi:[0,0,1]
    v_pk_fma_f32 v[128:129], v[20:21], v[162:163], v[134:135] op_sel:[0,0,1] op_sel_hi:[1,1,1] neg_lo:[1,0,1] neg_hi:[1,0,1]
    v_pk_fma_f32 v[144:145], v[28:29], v[162:163], v[150:151] op_sel:[0,0,1] op_sel_hi:[1,1,1] neg_lo:[1,0,1] neg_hi:[1,0,1]
    v_pk_fma_f32 v[20:21], v[20:21], v[162:163], v[134:135] op_sel_hi:[1,1,0] neg_lo:[0,0,1] neg_hi:[0,0,1]
    v_pk_fma_f32 v[28:29], v[28:29], v[162:163], v[150:151] op_sel_hi:[1,1,0] neg_lo:[0,0,1] neg_hi:[0,0,1]
    v_pk_fma_f32 v[130:131], v[22:23], v[162:163], v[134:135] op_sel:[0,0,1] op_sel_hi:[1,1,1] neg_lo:[1,0,1] neg_hi:[1,0,1]
    v_pk_fma_f32 v[146:147], v[30:31], v[162:163], v[150:151] op_sel:[0,0,1] op_sel_hi:[1,1,1] neg_lo:[1,0,1] neg_hi:[1,0,1]
    v_pk_fma_f32 v[22:23], v[22:23], v[162:163], v[134:135] op_sel_hi:[1,1,0] neg_lo:[0,0,1] neg_hi:[0,0,1]
    v_pk_fma_f32 v[30:31], v[30:31], v[162:163], v[150:151] op_sel_hi:[1,1,0] neg_lo:[0,0,1] neg_hi:[0,0,1]
    v_exp_f32 v16, v16
    v_exp_f32 v24, v24
    v_exp_f32 v124, v124
    v_exp_f32 v140, v140
    v_exp_f32 v17, v17
    v_exp_f32 v25, v25
    v_exp_f32 v125, v125
    v_exp_f32 v141, v141
    v_exp_f32 v18, v18
    v_exp_f32 v26, v26
    v_exp_f32 v126, v126
    v_exp_f32 v142, v142
    v_exp_f32 v19, v19
    v_exp_f32 v27, v27
    v_exp_f32 v127, v127
    v_exp_f32 v143, v143
    v_exp_f32 v20, v20
    v_exp_f32 v28, v28
    v_exp_f32 v128, v128
    v_exp_f32 v144, v144
    v_exp_f32 v21, v21
    v_exp_f32 v29, v29
    v_exp_f32 v129, v129
    v_exp_f32 v145, v145
    v_exp_f32 v22, v22
    v_exp_f32 v30, v30
    v_exp_f32 v130, v130
    v_exp_f32 v146, v146
    v_exp_f32 v23, v23
    v_exp_f32 v31, v31
    v_exp_f32 v131, v131
    v_exp_f32 v147, v147
    v_add_f32 v134, v16, v17
    v_add_f32 v150, v24, v25
    v_add_f32 v135, v124, v125
    v_add_f32 v151, v140, v141
    v_add_f32 v134, v134, v18
    v_add_f32 v150, v150, v26
    v_add_f32 v135, v135, v126
    v_add_f32 v151, v151, v142
    v_add_f32 v134, v134, v19
    v_add_f32 v150, v150, v27
    v_add_f32 v135, v135, v127
    v_add_f32 v151, v151, v143
    v_add_f32 v134, v134, v20
    v_add_f32 v150, v150, v28
    v_add_f32 v135, v135, v128
    v_add_f32 v151, v151, v144
    v_add_f32 v134, v134, v21
    v_add_f32 v150, v150, v29
    v_add_f32 v135, v135, v129
    v_add_f32 v151, v151, v145
    v_add_f32 v134, v134, v22
    v_add_f32 v150, v150, v30
    v_add_f32 v135, v135, v130
    v_add_f32 v151, v151, v146
    v_add_f32 v134, v134, v23
    v_add_f32 v150, v150, v31
    v_add_f32 v135, v135, v131
    v_add_f32 v151, v151, v147
    s_nop 0
    v_permlane32_swap_b32 v134, v135
    v_permlane32_swap_b32 v150, v151
    v_add_f32 v134, v134, v135
    v_add_f32 v150, v150, v151
    v_mov_b32 v120, v134
    v_mov_b32 v136, v150
    s_nop 0
    v_permlane16_swap_b32 v134, v120
    v_permlane16_swap_b32 v150, v136
    v_add_f32 v134, v134, v120
    v_add_f32 v150, v150, v136
    v_mov_b32 v135, v134
    v_mov_b32 v151, v150
    s_nop 0
    v_permlane32_swap_b32 v134, v135
    v_permlane32_swap_b32 v150, v151
    v_rcp_f32 v134, v134
    v_rcp_f32 v150, v150
    v_rcp_f32 v135, v135
    v_rcp_f32 v151, v151
    v_mul_f32 v16, v16, v134
    v_mul_f32 v24, v24, v150
    v_mul_f32 v124, v124, v135
    v_mul_f32 v140, v140, v151
    v_mul_f32 v17, v17, v134
    v_mul_f32 v25, v25, v150
    v_mul_f32 v125, v125, v135
    v_mul_f32 v141, v141, v151
    v_mul_f32 v18, v18, v134
    v_mul_f32 v26, v26, v150
    v_mul_f32 v126, v126, v135
    v_mul_f32 v142, v142, v151
    v_mul_f32 v19, v19, v134
    v_mul_f32 v27, v27, v150
    v_mul_f32 v127, v127, v135
    v_mul_f32 v143, v143, v151
    v_mul_f32 v20, v20, v134
    v_mul_f32 v28, v28, v150
    v_mul_f32 v128, v128, v135
    v_mul_f32 v144, v144, v151
    v_mul_f32 v21, v21, v134
    v_mul_f32 v29, v29, v150
    v_mul_f32 v129, v129, v135
    v_mul_f32 v145, v145, v151
    v_mul_f32 v22, v22, v134
    v_mul_f32 v30, v30, v150
    v_mul_f32 v130, v130, v135
    v_mul_f32 v146, v146, v151
    v_mul_f32 v23, v23, v134
    v_mul_f32 v31, v31, v150
    v_mul_f32 v131, v131, v135
    v_mul_f32 v147, v147, v151
    v_cvt_pk_bf16_f32 v72, v16, v17
    v_cvt_pk_bf16_f32 v80, v24, v25
    v_cvt_pk_bf16_f32 v76, v124, v125
    v_cvt_pk_bf16_f32 v84, v140, v141
    v_cvt_pk_bf16_f32 v73, v18, v19
    v_cvt_pk_bf16_f32 v81, v26, v27
    v_cvt_pk_bf16_f32 v77, v126, v127
    v_cvt_pk_bf16_f32 v85, v142, v143
    v_cvt_pk_bf16_f32 v74, v20, v21
    v_cvt_pk_bf16_f32 v82, v28, v29
    v_cvt_pk_bf16_f32 v78, v128, v129
    v_cvt_pk_bf16_f32 v86, v144, v145
    v_cvt_pk_bf16_f32 v75, v22, v23
    v_cvt_pk_bf16_f32 v83, v30, v31
    v_cvt_pk_bf16_f32 v79, v130, v131
    v_cvt_pk_bf16_f32 v87, v146, v147
    ds_write_b64 v9, v[72:73] offset:0
    ds_write_b64 v9, v[74:75] offset:32
    ds_write_b64 v9, v[76:77] offset:64
    ds_write_b64 v9, v[78:79] offset:96
    ds_write_b64 v9, v[80:81] offset:4224
    ds_write_b64 v9, v[82:83] offset:4256
    ds_write_b64 v9, v[84:85] offset:4288
    ds_write_b64 v9, v[86:87] offset:4320
    s_waitcnt lgkmcnt(0)
    s_barrier
    ds_read_b64_tr_b16 v[120:121], v12 offset:0
    ds_read_b64_tr_b16 v[122:123], v12 offset:72
    ds_read_b64_tr_b16 v[16:17], v11 offset:0
    ds_read_b64_tr_b16 v[18:19], v11 offset:264
    ds_read_b64_tr_b16 v[20:21], v11 offset:32
    ds_read_b64_tr_b16 v[22:23], v11 offset:296
    ds_read_b64_tr_b16 v[124:125], v12 offset:2304
    ds_read_b64_tr_b16 v[126:127], v12 offset:2376
    ds_read_b64_tr_b16 v[24:25], v11 offset:8448
    ds_read_b64_tr_b16 v[26:27], v11 offset:8712
    ds_read_b64_tr_b16 v[28:29], v11 offset:8480
    ds_read_b64_tr_b16 v[30:31], v11 offset:8744
    s_waitcnt lgkmcnt(8)
    v_mfma_f32_16x16x32_bf16 v[136:139], v[16:19], v[120:123], 0
    s_waitcnt lgkmcnt(6)
    v_mfma_f32_16x16x32_bf16 v[140:143], v[20:23], v[120:123], 0
    ds_read_b64_tr_b16 v[128:129], v12 offset:4608
    ds_read_b64_tr_b16 v[130:131], v12 offset:4680
    ds_read_b64_tr_b16 v[32:33], v11 offset:16896
    ds_read_b64_tr_b16 v[34:35], v11 offset:17160
    ds_read_b64_tr_b16 v[36:37], v11 offset:16928
    ds_read_b64_tr_b16 v[38:39], v11 offset:17192
    s_waitcnt lgkmcnt(8)
    v_mfma_f32_16x16x32_bf16 v[136:139], v[24:27], v[124:127], v[136:139]
    s_waitcnt lgkmcnt(6)
    v_mfma_f32_16x16x32_bf16 v[140:143], v[28:31], v[124:127], v[140:143]
    ds_read_b64_tr_b16 v[132:133], v12 offset:6912
    ds_read_b64_tr_b16 v[134:135], v12 offset:6984
    ds_read_b64_tr_b16 v[40:41], v11 offset:25344
    ds_read_b64_tr_b16 v[42:43], v11 offset:25608
    ds_read_b64_tr_b16 v[44:45], v11 offset:25376
    ds_read_b64_tr_b16 v[46:47], v11 offset:25640
    s_waitcnt lgkmcnt(8)
    v_mfma_f32_16x16x32_bf16 v[136:139], v[32:35], v[128:131], v[136:139]
    s_waitcnt lgkmcnt(6)
    v_mfma_f32_16x16x32_bf16 v[140:143], v[36:39], v[128:131], v[140:143]
    s_waitcnt lgkmcnt(2)
    v_mfma_f32_16x16x32_bf16 v[136:139], v[40:43], v[132:135], v[136:139]
    s_waitcnt lgkmcnt(0)
    v_mfma_f32_16x16x32_bf16 v[140:143], v[44:47], v[132:135], v[140:143]
    s_nop 5
    v_cvt_pk_bf16_f32 v152, v136, v137
    v_cvt_pk_bf16_f32 v153, v138, v139
    v_cvt_pk_bf16_f32 v154, v140, v141
    v_cvt_pk_bf16_f32 v155, v142, v143
    v_min_u32 v152, -2, v152
    v_min_u32 v153, -2, v153
    v_min_u32 v154, -2, v154
    v_min_u32 v155, -2, v155
    buffer_store_dwordx4 v[152:155], v14, s[16:19], 0 offen sc1
    s_barrier
    s_lshl_b32 s47, s41, 17
    s_lshl_b32 s48, s43, 10
    s_add_u32 s47, s47, s48
    s_add_u32 s47, s47, 4194304
    v_add_u32 v10, s47, v3
    v_cvt_pk_bf16_f32 v16, v48, v49
    v_cvt_pk_bf16_f32 v32, v56, v57
    v_cvt_pk_bf16_f32 v17, v50, v51
    v_cvt_pk_bf16_f32 v33, v58, v59
    v_cvt_pk_bf16_f32 v18, v52, v53
    v_cvt_pk_bf16_f32 v34, v60, v61
    v_cvt_pk_bf16_f32 v19, v54, v55
    v_cvt_pk_bf16_f32 v35, v62, v63
    v_cndmask_b32 v18, v18, 0, s[66:67]
    v_cndmask_b32 v34, v34, 0, s[66:67]
    v_cndmask_b32 v19, v19, 0, s[66:67]
    v_cndmask_b32 v35, v35, 0, s[66:67]
    s_nop 0
    v_mfma_f32_16x16x32_bf16 v[48:51], v[64:67], v[16:19], 0
    v_mfma_f32_16x16x32_bf16 v[56:59], v[64:67], v[32:35], 0
    v_mfma_f32_16x16x32_bf16 v[52:55], v[68:71], v[16:19], 0
    v_mfma_f32_16x16x32_bf16 v[60:63], v[68:71], v[32:35], 0
    s_nop 4
    v_cvt_pk_bf16_f32 v16, v48, v49
    v_cvt_pk_bf16_f32 v32, v56, v57
    v_cvt_pk_bf16_f32 v17, v50, v51
    v_cvt_pk_bf16_f32 v33, v58, v59
    v_cvt_pk_bf16_f32 v18, v52, v53
    v_cvt_pk_bf16_f32 v34, v60, v61
    v_cvt_pk_bf16_f32 v19, v54, v55
    v_cvt_pk_bf16_f32 v35, v62, v63
    v_lshlrev_b32 v48, 16, v16
    v_lshlrev_b32 v56, 16, v32
    v_and_b32 v49, s67, v16
    v_and_b32 v57, s67, v32
    v_lshlrev_b32 v50, 16, v17
    v_lshlrev_b32 v58, 16, v33
    v_and_b32 v51, s67, v17
    v_and_b32 v59, s67, v33
    v_lshlrev_b32 v52, 16, v18
    v_lshlrev_b32 v60, 16, v34
    v_and_b32 v53, s67, v18
    v_and_b32 v61, s67, v34
    v_lshlrev_b32 v54, 16, v19
    v_lshlrev_b32 v62, 16, v35
    v_and_b32 v55, s67, v19
    v_and_b32 v63, s67, v35
    v_max3_f32 v28, v48, v49, v50
    v_max3_f32 v44, v56, v57, v58
    v_min3_f32 v29, v48, v49, v50
    v_min3_f32 v45, v56, v57, v58
    v_max3_f32 v28, v28, v51, v52
    v_max3_f32 v44, v44, v59, v60
    v_min3_f32 v29, v29, v51, v52
    v_min3_f32 v45, v45, v59, v60
    v_max3_f32 v28, v28, v53, v54
    v_max3_f32 v44, v44, v61, v62
    v_min3_f32 v29, v29, v53, v54
    v_min3_f32 v45, v45, v61, v62
    v_max_f32 v28, v28, v55
    v_max_f32 v44, v44, v63
    v_max_f32 v29, -v29, -v55
    v_max_f32 v45, -v45, -v63
    s_nop 0
    v_permlane32_swap_b32 v28, v29
    v_permlane32_swap_b32 v44, v45
    v_max_f32 v28, v28, v29
    v_max_f32 v44, v44, v45
    v_mov_b32 v16, v28
    v_mov_b32 v32, v44
    s_nop 0
    v_permlane16_swap_b32 v28, v16
    v_permlane16_swap_b32 v44, v32
    v_max_f32 v28, v28, v16
    v_max_f32 v44, v44, v32
    v_mov_b32 v29, v28
    v_mov_b32 v45, v44
    s_nop 0
    v_permlane32_swap_b32 v28, v29
    v_permlane32_swap_b32 v44, v45
    v_mul_f32 v28, s68, v28
    v_mul_f32 v44, s68, v44
    v_mul_f32 v29, s68, v29
    v_mul_f32 v45, s68, v45
    v_add_f32 v30, v28, v7
    v_add_f32 v46, v44, v7
    v_add_f32 v31, v29, v7
    v_add_f32 v47, v45, v7
    v_pk_fma_f32 v[20:21], v[48:49], v[162:163], v[28:29] op_sel:[0,0,1] op_sel_hi:[1,1,1] neg_lo:[1,0,1] neg_hi:[1,0,1]
    v_pk_fma_f32 v[36:37], v[56:57], v[162:163], v[44:45] op_sel:[0,0,1] op_sel_hi:[1,1,1] neg_lo:[1,0,1] neg_hi:[1,0,1]
    v_pk_fma_f32 v[48:49], v[48:49], v[162:163], v[28:29] op_sel_hi:[1,1,0] neg_lo:[0,0,1] neg_hi:[0,0,1]
    v_pk_fma_f32 v[56:57], v[56:57], v[162:163], v[44:45] op_sel_hi:[1,1,0] neg_lo:[0,0,1] neg_hi:[0,0,1]
    v_pk_fma_f32 v[22:23], v[50:51], v[162:163], v[28:29] op_sel:[0,0,1] op_sel_hi:[1,1,1] neg_lo:[1,0,1] neg_hi:[1,0,1]
    v_pk_fma_f32 v[38:39], v[58:59], v[162:163], v[44:45] op_sel:[0,0,1] op_sel_hi:[1,1,1] neg_lo:[1,0,1] neg_hi:[1,0,1]
    v_pk_fma_f32 v[50:51], v[50:51], v[162:163], v[28:29] op_sel_hi:[1,1,0] neg_lo:[0,0,1] neg_hi:[0,0,1]
    v_pk_fma_f32 v[58:59], v[58:59], v[162:163], v[44:45] op_sel_hi:[1,1,0] neg_lo:[0,0,1] neg_hi:[0,0,1]
    v_pk_fma_f32 v[24:25], v[52:53], v[162:163], v[30:31] op_sel:[0,0,1] op_sel_hi:[1,1,1] neg_lo:[1,0,1] neg_hi:[1,0,1]
    v_pk_fma_f32 v[40:41], v[60:61], v[162:163], v[46:47] op_sel:[0,0,1] op_sel_hi:[1,1,1] neg_lo:[1,0,1] neg_hi:[1,0,1]
    v_pk_fma_f32 v[52:53], v[52:53], v[162:163], v[30:31] op_sel_hi:[1,1,0] neg_lo:[0,0,1] neg_hi:[0,0,1]
    v_pk_fma_f32 v[60:61], v[60:61], v[162:163], v[46:47] op_sel_hi:[1,1,0] neg_lo:[0,0,1] neg_hi:[0,0,1]
    v_pk_fma_f32 v[26:27], v[54:55], v[162:163], v[30:31] op_sel:[0,0,1] op_sel_hi:[1,1,1] neg_lo:[1,0,1] neg_hi:[1,0,1]
    v_pk_fma_f32 v[42:43], v[62:63], v[162:163], v[46:47] op_sel:[0,0,1] op_sel_hi:[1,1,1] neg_lo:[1,0,1] neg_hi:[1,0,1]
    v_pk_fma_f32 v[54:55], v[54:55], v[162:163], v[30:31] op_sel_hi:[1,1,0] neg_lo:[0,0,1] neg_hi:[0,0,1]
    v_pk_fma_f32 v[62:63], v[62:63], v[162:163], v[46:47] op_sel_hi:[1,1,0] neg_lo:[0,0,1] neg_hi:[0,0,1]
    v_exp_f32 v48, v48
    v_exp_f32 v56, v56
    v_exp_f32 v20, v20
    v_exp_f32 v36, v36
    v_exp_f32 v49, v49
    v_exp_f32 v57, v57
    v_exp_f32 v21, v21
    v_exp_f32 v37, v37
    v_exp_f32 v50, v50
    v_exp_f32 v58, v58
    v_exp_f32 v22, v22
    v_exp_f32 v38, v38
    v_exp_f32 v51, v51
    v_exp_f32 v59, v59
    v_exp_f32 v23, v23
    v_exp_f32 v39, v39
    v_exp_f32 v52, v52
    v_exp_f32 v60, v60
    v_exp_f32 v24, v24
    v_exp_f32 v40, v40
    v_exp_f32 v53, v53
    v_exp_f32 v61, v61
    v_exp_f32 v25, v25
    v_exp_f32 v41, v41
    v_exp_f32 v54, v54
    v_exp_f32 v62, v62
    v_exp_f32 v26, v26
    v_exp_f32 v42, v42
    v_exp_f32 v55, v55
    v_exp_f32 v63, v63
    v_exp_f32 v27, v27
    v_exp_f32 v43, v43
    v_add_f32 v30, v48, v49
    v_add_f32 v46, v56, v57
    v_add_f32 v31, v20, v21
    v_add_f32 v47, v36, v37
    v_add_f32 v30, v30, v50
    v_add_f32 v46, v46, v58
    v_add_f32 v31, v31, v22
    v_add_f32 v47, v47, v38
    v_add_f32 v30, v30, v51
    v_add_f32 v46, v46, v59
    v_add_f32 v31, v31, v23
    v_add_f32 v47, v47, v39
    v_add_f32 v30, v30, v52
    v_add_f32 v46, v46, v60
    v_add_f32 v31, v31, v24
    v_add_f32 v47, v47, v40
    v_add_f32 v30, v30, v53
    v_add_f32 v46, v46, v61
    v_add_f32 v31, v31, v25
    v_add_f32 v47, v47, v41
    v_add_f32 v30, v30, v54
    v_add_f32 v46, v46, v62
    v_add_f32 v31, v31, v26
    v_add_f32 v47, v47, v42
    v_add_f32 v30, v30, v55
    v_add_f32 v46, v46, v63
    v_add_f32 v31, v31, v27
    v_add_f32 v47, v47, v43
    s_nop 0
    v_permlane32_swap_b32 v30, v31
    v_permlane32_swap_b32 v46, v47
    v_add_f32 v30, v30, v31
    v_add_f32 v46, v46, v47
    v_mov_b32 v16, v30
    v_mov_b32 v32, v46
    s_nop 0
    v_permlane16_swap_b32 v30, v16
    v_permlane16_swap_b32 v46, v32
    v_add_f32 v30, v30, v16
    v_add_f32 v46, v46, v32
    v_mov_b32 v31, v30
    v_mov_b32 v47, v46
    s_nop 0
    v_permlane32_swap_b32 v30, v31
    v_permlane32_swap_b32 v46, v47
    v_rcp_f32 v30, v30
    v_rcp_f32 v46, v46
    v_rcp_f32 v31, v31
    v_rcp_f32 v47, v47
    v_mul_f32 v48, v48, v30
    v_mul_f32 v56, v56, v46
    v_mul_f32 v20, v20, v31
    v_mul_f32 v36, v36, v47
    v_mul_f32 v49, v49, v30
    v_mul_f32 v57, v57, v46
    v_mul_f32 v21, v21, v31
    v_mul_f32 v37, v37, v47
    v_mul_f32 v50, v50, v30
    v_mul_f32 v58, v58, v46
    v_mul_f32 v22, v22, v31
    v_mul_f32 v38, v38, v47
    v_mul_f32 v51, v51, v30
    v_mul_f32 v59, v59, v46
    v_mul_f32 v23, v23, v31
    v_mul_f32 v39, v39, v47
    v_mul_f32 v52, v52, v30
    v_mul_f32 v60, v60, v46
    v_mul_f32 v24, v24, v31
    v_mul_f32 v40, v40, v47
    v_mul_f32 v53, v53, v30
    v_mul_f32 v61, v61, v46
    v_mul_f32 v25, v25, v31
    v_mul_f32 v41, v41, v47
    v_mul_f32 v54, v54, v30
    v_mul_f32 v62, v62, v46
    s_barrier
    s_mov_b32 s47, 0
    buffer_load_dwordx4 v[88:91], v10, s[16:19], s47 offen sc1
    s_mov_b32 s47, 8192
    buffer_load_dwordx4 v[92:95], v10, s[16:19], s47 offen sc1
    s_mov_b32 s47, 16384
    buffer_load_dwordx4 v[96:99], v10, s[16:19], s47 offen sc1
    s_mov_b32 s47, 24576
    buffer_load_dwordx4 v[100:103], v10, s[16:19], s47 offen sc1
    s_mov_b32 s47, 32768
    buffer_load_dwordx4 v[104:107], v10, s[16:19], s47 offen sc1
    s_mov_b32 s47, 40960
    buffer_load_dwordx4 v[108:111], v10, s[16:19], s47 offen sc1
    s_mov_b32 s47, 49152
    buffer_load_dwordx4 v[112:115], v10, s[16:19], s47 offen sc1
    s_mov_b32 s47, 57344
    buffer_load_dwordx4 v[116:119], v10, s[16:19], s47 offen sc1
    s_mov_b32 s47, 65536
    buffer_load_dwordx4 v[120:123], v10, s[16:19], s47 offen sc1
    s_mov_b32 s47, 73728
    buffer_load_dwordx4 v[124:127], v10, s[16:19], s47 offen sc1
    s_mov_b32 s47, 81920
    buffer_load_dwordx4 v[128:131], v10, s[16:19], s47 offen sc1
    s_mov_b32 s47, 90112
    buffer_load_dwordx4 v[132:135], v10, s[16:19], s47 offen sc1
    s_mov_b32 s47, 98304
    buffer_load_dwordx4 v[136:139], v10, s[16:19], s47 offen sc1
    s_mov_b32 s47, 106496
    buffer_load_dwordx4 v[140:143], v10, s[16:19], s47 offen sc1
    s_mov_b32 s47, 114688
    buffer_load_dwordx4 v[144:147], v10, s[16:19], s47 offen sc1
    s_mov_b32 s47, 122880
    buffer_load_dwordx4 v[148:151], v10, s[16:19], s47 offen sc1
    v_mul_f32 v26, v26, v31
    v_mul_f32 v42, v42, v47
    v_mul_f32 v55, v55, v30
    v_mul_f32 v63, v63, v46
    v_mul_f32 v27, v27, v31
    v_mul_f32 v43, v43, v47
    v_cvt_pk_bf16_f32 v72, v48, v49
    v_cvt_pk_bf16_f32 v80, v56, v57
    v_cvt_pk_bf16_f32 v76, v20, v21
    v_cvt_pk_bf16_f32 v84, v36, v37
    v_cvt_pk_bf16_f32 v73, v50, v51
    v_cvt_pk_bf16_f32 v81, v58, v59
    v_cvt_pk_bf16_f32 v77, v22, v23
    v_cvt_pk_bf16_f32 v85, v38, v39
    v_cvt_pk_bf16_f32 v74, v52, v53
    v_cvt_pk_bf16_f32 v82, v60, v61
    v_cvt_pk_bf16_f32 v78, v24, v25
    v_cvt_pk_bf16_f32 v86, v40, v41
    v_cvt_pk_bf16_f32 v75, v54, v55
    v_cvt_pk_bf16_f32 v83, v62, v63
    v_cvt_pk_bf16_f32 v79, v26, v27
    v_cvt_pk_bf16_f32 v87, v42, v43
    s_and_b32 s50, s43, 3
    s_lshr_b32 s51, s43, 2
    s_lshl_b32 s71, s44, 2
    s_add_u32 s71, s71, s50
    s_lshl_b32 s52, s71, 14
    s_lshl_b32 s53, s51, 13
    s_add_u32 s52, s52, s53
    v_add_u32 v4, s52, v3
    s_lshl_b32 s71, s71, 4
    v_add_u32 v5, s71, v1
    v_bfe_u32 v160, v0, 2, 2
    v_lshl_add_u32 v160, v2, 2, v160
    v_bfe_u32 v161, v160, 1, 2
    v_and_b32 v153, 3, v0
    v_lshlrev_b32 v153, 3, v153
    v_lshl_add_u32 v153, v160, 7, v153
    s_mul_i32 s71, s51, 28672
    s_add_u32 s71, s71, 58368
    v_add_u32 v153, s71, v153
    s_lshl_b32 s71, s51, 1
    v_xor_b32 v161, s71, v161
    v_xor_b32 v160, 0, v161
    v_lshl_add_u32 v12, v160, 5, v153
    v_xor_b32 v160, 1, v161
    v_lshl_add_u32 v13, v160, 5, v153
    v_xor_b32 v160, 2, v161
    v_lshl_add_u32 v14, v160, 5, v153
    v_xor_b32 v160, 3, v161
    v_lshl_add_u32 v15, v160, 5, v153
    v_add_u32 v7, 4096, v4
    v_lshlrev_b32 v9, 2, v5
    v_add_u32 v9, 5242880, v9
    v_lshrrev_b32 v24, 2, v1
    v_cmp_eq_u32 vcc, v24, v2
    v_and_b32 v24, 1, v1
    v_lshlrev_b32 v24, 4, v24
    v_mov_b32 v25, 0x3f80
    v_lshlrev_b32 v24, v24, v25
    v_cndmask_b32 v24, 0, v24, vcc
    v_and_b32 v25, 2, v1
    v_cmp_eq_u32 vcc, 0, v25
    v_mov_b32 v154, 0
    v_mov_b32 v155, 0
    v_mov_b32 v158, 0
    v_mov_b32 v159, 0
    v_cndmask_b32 v156, 0, v24, vcc
    v_cndmask_b32 v157, v24, 0, vcc
    s_mov_b32 s70, 0
    s_nop 0
    s_branch L_kvc_16
L_kv_15:
    s_mov_b32 s47, 0
    buffer_load_dwordx4 v[88:91], v10, s[16:19], s47 offen sc1
    s_mov_b32 s47, 8192
    buffer_load_dwordx4 v[92:95], v10, s[16:19], s47 offen sc1
    s_mov_b32 s47, 16384
    buffer_load_dwordx4 v[96:99], v10, s[16:19], s47 offen sc1
    s_mov_b32 s47, 24576
    buffer_load_dwordx4 v[100:103], v10, s[16:19], s47 offen sc1
    s_mov_b32 s47, 32768
    buffer_load_dwordx4 v[104:107], v10, s[16:19], s47 offen sc1
    s_mov_b32 s47, 40960
    buffer_load_dwordx4 v[108:111], v10, s[16:19], s47 offen sc1
    s_mov_b32 s47, 49152
    buffer_load_dwordx4 v[112:115], v10, s[16:19], s47 offen sc1
    s_mov_b32 s47, 57344
    buffer_load_dwordx4 v[116:119], v10, s[16:19], s47 offen sc1
    s_mov_b32 s47, 65536
    buffer_load_dwordx4 v[120:123], v10, s[16:19], s47 offen sc1
    s_mov_b32 s47, 73728
    buffer_load_dwordx4 v[124:127], v10, s[16:19], s47 offen sc1
    s_mov_b32 s47, 81920
    buffer_load_dwordx4 v[128:131], v10, s[16:19], s47 offen sc1
    s_mov_b32 s47, 90112
    buffer_load_dwordx4 v[132:135], v10, s[16:19], s47 offen sc1
    s_mov_b32 s47, 98304
    buffer_load_dwordx4 v[136:139], v10, s[16:19], s47 offen sc1
    s_mov_b32 s47, 106496
    buffer_load_dwordx4 v[140:143], v10, s[16:19], s47 offen sc1
    s_mov_b32 s47, 114688
    buffer_load_dwordx4 v[144:147], v10, s[16:19], s47 offen sc1
    s_mov_b32 s47, 122880
    buffer_load_dwordx4 v[148:151], v10, s[16:19], s47 offen sc1
L_kvc_16:
    s_waitcnt vmcnt(15)
    v_mfma_f32_16x16x32_bf16 v[16:19], v[156:159], v[88:91], 0
    v_mfma_f32_16x16x32_bf16 v[20:23], v[154:157], v[88:91], 0
    v_max_u32 v152, v88, v89
    v_max3_u32 v152, v152, v90, v91
    s_waitcnt vmcnt(14)
    v_mfma_f32_16x16x32_bf16 v[16:19], v[156:159], v[92:95], v[16:19]
    v_mfma_f32_16x16x32_bf16 v[20:23], v[154:157], v[92:95], v[20:23]
    v_max3_u32 v152, v152, v92, v93
    v_max3_u32 v152, v152, v94, v95
    s_waitcnt vmcnt(13)
    v_mfma_f32_16x16x32_bf16 v[16:19], v[156:159], v[96:99], v[16:19]
    v_mfma_f32_16x16x32_bf16 v[20:23], v[154:157], v[96:99], v[20:23]
    v_max3_u32 v152, v152, v96, v97
    v_max3_u32 v152, v152, v98, v99
    s_waitcnt vmcnt(12)
    v_mfma_f32_16x16x32_bf16 v[16:19], v[156:159], v[100:103], v[16:19]
    v_mfma_f32_16x16x32_bf16 v[20:23], v[154:157], v[100:103], v[20:23]
    v_max3_u32 v152, v152, v100, v101
    v_max3_u32 v152, v152, v102, v103
    s_waitcnt vmcnt(11)
    v_mfma_f32_16x16x32_bf16 v[16:19], v[156:159], v[104:107], v[16:19]
    v_mfma_f32_16x16x32_bf16 v[20:23], v[154:157], v[104:107], v[20:23]
    v_max3_u32 v152, v152, v104, v105
    v_max3_u32 v152, v152, v106, v107
    s_waitcnt vmcnt(10)
    v_mfma_f32_16x16x32_bf16 v[16:19], v[156:159], v[108:111], v[16:19]
    v_mfma_f32_16x16x32_bf16 v[20:23], v[154:157], v[108:111], v[20:23]
    v_max3_u32 v152, v152, v108, v109
    v_max3_u32 v152, v152, v110, v111
    s_waitcnt vmcnt(9)
    v_mfma_f32_16x16x32_bf16 v[16:19], v[156:159], v[112:115], v[16:19]
    v_mfma_f32_16x16x32_bf16 v[20:23], v[154:157], v[112:115], v[20:23]
    v_max3_u32 v152, v152, v112, v113
    v_max3_u32 v152, v152, v114, v115
    s_waitcnt vmcnt(8)
    v_mfma_f32_16x16x32_bf16 v[16:19], v[156:159], v[116:119], v[16:19]
    v_mfma_f32_16x16x32_bf16 v[20:23], v[154:157], v[116:119], v[20:23]
    v_max3_u32 v152, v152, v116, v117
    v_max3_u32 v152, v152, v118, v119
    s_waitcnt vmcnt(7)
    v_mfma_f32_16x16x32_bf16 v[16:19], v[156:159], v[120:123], v[16:19]
    v_mfma_f32_16x16x32_bf16 v[20:23], v[154:157], v[120:123], v[20:23]
    v_max3_u32 v152, v152, v120, v121
    v_max3_u32 v152, v152, v122, v123
    s_waitcnt vmcnt(6)
    v_mfma_f32_16x16x32_bf16 v[16:19], v[156:159], v[124:127], v[16:19]
    v_mfma_f32_16x16x32_bf16 v[20:23], v[154:157], v[124:127], v[20:23]
    v_max3_u32 v152, v152, v124, v125
    v_max3_u32 v152, v152, v126, v127
    s_waitcnt vmcnt(5)
    v_mfma_f32_16x16x32_bf16 v[16:19], v[156:159], v[128:131], v[16:19]
    v_mfma_f32_16x16x32_bf16 v[20:23], v[154:157], v[128:131], v[20:23]
    v_max3_u32 v152, v152, v128, v129
    v_max3_u32 v152, v152, v130, v131
    s_waitcnt vmcnt(4)
    v_mfma_f32_16x16x32_bf16 v[16:19], v[156:159], v[132:135], v[16:19]
    v_mfma_f32_16x16x32_bf16 v[20:23], v[154:157], v[132:135], v[20:23]
    v_max3_u32 v152, v152, v132, v133
    v_max3_u32 v152, v152, v134, v135
    s_waitcnt vmcnt(3)
    v_mfma_f32_16x16x32_bf16 v[16:19], v[156:159], v[136:139], v[16:19]
    v_mfma_f32_16x16x32_bf16 v[20:23], v[154:157], v[136:139], v[20:23]
    v_max3_u32 v152, v152, v136, v137
    v_max3_u32 v152, v152, v138, v139
    s_waitcnt vmcnt(2)
    v_mfma_f32_16x16x32_bf16 v[16:19], v[156:159], v[140:143], v[16:19]
    v_mfma_f32_16x16x32_bf16 v[20:23], v[154:157], v[140:143], v[20:23]
    v_max3_u32 v152, v152, v140, v141
    v_max3_u32 v152, v152, v142, v143
    s_waitcnt vmcnt(1)
    v_mfma_f32_16x16x32_bf16 v[16:19], v[156:159], v[144:147], v[16:19]
    v_mfma_f32_16x16x32_bf16 v[20:23], v[154:157], v[144:147], v[20:23]
    v_max3_u32 v152, v152, v144, v145
    v_max3_u32 v152, v152, v146, v147
    s_waitcnt vmcnt(0)
    v_mfma_f32_16x16x32_bf16 v[16:19], v[156:159], v[148:151], v[16:19]
    v_mfma_f32_16x16x32_bf16 v[20:23], v[154:157], v[148:151], v[20:23]
    v_max3_u32 v152, v152, v148, v149
    v_max3_u32 v152, v152, v150, v151
    v_cmp_eq_u32 vcc, -1, v152
    s_nop 0
    s_cbranch_vccz L_kvd_17
    s_add_u32 s70, s70, 1
    s_cmp_lt_u32 s70, 30000
    s_cbranch_scc0 L_kvd_17
    s_sleep 2
    s_branch L_kv_15
L_kvd_17:
    v_cvt_pk_bf16_f32 v24, v16, v17
    v_cvt_pk_bf16_f32 v25, v18, v19
    v_cvt_pk_bf16_f32 v26, v20, v21
    v_cvt_pk_bf16_f32 v27, v22, v23
    s_lshl_b32 s47, s43, 10
    s_add_u32 s47, s47, 143360
    v_add_u32 v10, s47, v3
    ds_write_b128 v10, v[24:27]
    s_lshl_b32 s47, s4, 12
    s_add_u32 s47, s47, 143360
    v_add_u32 v10, s47, v3
    v_lshlrev_b32 v11, 8, v2
    s_add_u32 s47, s47, 192
    v_add_u32 v11, s47, v11
    s_waitcnt lgkmcnt(0)
    s_barrier
    ds_read_b128 v[88:91], v10 offset:0
    ds_read_b128 v[92:95], v10 offset:1024
    ds_read_b128 v[96:99], v10 offset:2048
    ds_read_b128 v[100:103], v10 offset:3072
    ds_read_b128 v[104:107], v11 offset:1024
    ds_read_b128 v[108:111], v11 offset:3072
    s_waitcnt lgkmcnt(5)
    v_mfma_f32_16x16x32_bf16 v[112:115], v[88:91], v[72:75], 0
    s_waitcnt lgkmcnt(3)
    v_mfma_f32_16x16x32_bf16 v[112:115], v[96:99], v[76:79], v[112:115]
    v_mfma_f32_16x16x32_bf16 v[116:119], v[92:95], v[72:75], 0
    s_waitcnt lgkmcnt(2)
    v_mfma_f32_16x16x32_bf16 v[116:119], v[100:103], v[76:79], v[116:119]
    s_waitcnt lgkmcnt(1)
    v_mfma_f32_16x16x32_bf16 v[120:123], v[104:107], v[72:75], 0
    s_waitcnt lgkmcnt(0)
    v_mfma_f32_16x16x32_bf16 v[120:123], v[108:111], v[76:79], v[120:123]
    v_mfma_f32_16x16x32_bf16 v[124:127], v[88:91], v[80:83], 0
    v_mfma_f32_16x16x32_bf16 v[124:127], v[96:99], v[84:87], v[124:127]
    v_mfma_f32_16x16x32_bf16 v[128:131], v[92:95], v[80:83], 0
    v_mfma_f32_16x16x32_bf16 v[128:131], v[100:103], v[84:87], v[128:131]
    v_mfma_f32_16x16x32_bf16 v[132:135], v[104:107], v[80:83], 0
    v_mfma_f32_16x16x32_bf16 v[132:135], v[108:111], v[84:87], v[132:135]
    v_cvt_pk_bf16_f32 v136, v112, v113
    s_nop 2
    v_cvt_pk_bf16_f32 v144, v124, v125
    v_cvt_pk_bf16_f32 v137, v114, v115
    v_cvt_pk_bf16_f32 v145, v126, v127
    v_cvt_pk_bf16_f32 v138, v116, v117
    v_cvt_pk_bf16_f32 v146, v128, v129
    v_cvt_pk_bf16_f32 v139, v118, v119
    v_cvt_pk_bf16_f32 v147, v130, v131
    v_lshlrev_b32 v112, 16, v136
    v_lshlrev_b32 v124, 16, v144
    v_and_b32 v113, s67, v136
    v_and_b32 v125, s67, v144
    v_lshlrev_b32 v114, 16, v137
    v_lshlrev_b32 v126, 16, v145
    v_and_b32 v115, s67, v137
    v_and_b32 v127, s67, v145
    v_lshlrev_b32 v116, 16, v138
    v_lshlrev_b32 v128, 16, v146
    v_and_b32 v117, s67, v138
    v_and_b32 v129, s67, v146
    v_lshlrev_b32 v118, 16, v139
    v_lshlrev_b32 v130, 16, v147
    v_and_b32 v119, s67, v139
    v_and_b32 v131, s67, v147
    v_cvt_pk_bf16_f32 v140, v120, v120
    v_cvt_pk_bf16_f32 v148, v132, v132
    v_lshlrev_b32 v120, 16, v140
    v_lshlrev_b32 v132, 16, v148
    v_add_f32 v120, 0x358637bd, v120
    v_add_f32 v132, 0x358637bd, v132
    v_cvt_pk_bf16_f32 v140, v120, v120
    v_cvt_pk_bf16_f32 v148, v132, v132
    v_lshlrev_b32 v120, 16, v140
    v_lshlrev_b32 v132, 16, v148
    v_rcp_f32 v120, v120
    v_rcp_f32 v132, v132
    v_mul_f32 v112, v112, v120
    v_mul_f32 v124, v124, v132
    v_mul_f32 v113, v113, v120
    v_mul_f32 v125, v125, v132
    v_mul_f32 v114, v114, v120
    v_mul_f32 v126, v126, v132
    v_mul_f32 v115, v115, v120
    v_mul_f32 v127, v127, v132
    v_mul_f32 v116, v116, v120
    v_mul_f32 v128, v128, v132
    v_mul_f32 v117, v117, v120
    v_mul_f32 v129, v129, v132
    v_mul_f32 v118, v118, v120
    v_mul_f32 v130, v130, v132
    v_mul_f32 v119, v119, v120
    v_mul_f32 v131, v131, v132
    v_cvt_pk_bf16_f32 v136, v112, v113
    v_cvt_pk_bf16_f32 v144, v124, v125
    v_cvt_pk_bf16_f32 v137, v114, v115
    v_cvt_pk_bf16_f32 v145, v126, v127
    v_cvt_pk_bf16_f32 v138, v116, v117
    v_cvt_pk_bf16_f32 v146, v128, v129
    v_cvt_pk_bf16_f32 v139, v118, v119
    v_cvt_pk_bf16_f32 v147, v130, v131
    v_cndmask_b32 v138, v138, 0, s[66:67]
    v_cndmask_b32 v146, v146, 0, s[66:67]
    v_cndmask_b32 v139, v139, 0, s[66:67]
    v_cndmask_b32 v147, v147, 0, s[66:67]
    v_min_u32 v136, -2, v136
    v_min_u32 v144, -2, v144
    v_min_u32 v137, -2, v137
    v_min_u32 v145, -2, v145
    v_min_u32 v138, -2, v138
    v_min_u32 v146, -2, v146
    v_min_u32 v139, -2, v139
    v_min_u32 v147, -2, v147
    buffer_store_dwordx4 v[136:139], v8, s[16:19], 0 offen sc1
    buffer_store_dwordx4 v[144:147], v8, s[16:19], s5 offen sc1
    s_mov_b32 s71, 0
    buffer_load_dwordx4 v[16:19], v4, s[16:19], s71 offen offset:0 sc1
    buffer_load_dwordx4 v[20:23], v4, s[16:19], s71 offen offset:1024 sc1
    buffer_load_dwordx4 v[24:27], v4, s[16:19], s71 offen offset:2048 sc1
    buffer_load_dwordx4 v[28:31], v4, s[16:19], s71 offen offset:3072 sc1
    buffer_load_dwordx4 v[32:35], v7, s[16:19], s71 offen offset:0 sc1
    buffer_load_dwordx4 v[36:39], v7, s[16:19], s71 offen offset:1024 sc1
    buffer_load_dwordx4 v[40:43], v7, s[16:19], s71 offen offset:2048 sc1
    buffer_load_dwordx4 v[44:47], v7, s[16:19], s71 offen offset:3072 sc1
    buffer_load_dword v6, v9, s[16:19], 0 offen sc1
L_p3:
    s_cmp_ge_u32 s46, 28
    s_cbranch_scc1 L_fin
    s_barrier
    s_cmp_lg_u32 s42, 0
    s_cbranch_scc1 L_p3a_18
    s_mov_b32 s71, 0
    buffer_load_dwordx4 v[16:19], v4, s[16:19], s71 offen offset:0 sc1
    buffer_load_dwordx4 v[20:23], v4, s[16:19], s71 offen offset:1024 sc1
    buffer_load_dwordx4 v[24:27], v4, s[16:19], s71 offen offset:2048 sc1
    buffer_load_dwordx4 v[28:31], v4, s[16:19], s71 offen offset:3072 sc1
    buffer_load_dwordx4 v[32:35], v7, s[16:19], s71 offen offset:0 sc1
    buffer_load_dwordx4 v[36:39], v7, s[16:19], s71 offen offset:1024 sc1
    buffer_load_dwordx4 v[40:43], v7, s[16:19], s71 offen offset:2048 sc1
    buffer_load_dwordx4 v[44:47], v7, s[16:19], s71 offen offset:3072 sc1
    buffer_load_dword v6, v9, s[16:19], 0 offen sc1
L_p3a_18:
    s_lshl_b32 s47, s43, 12
    s_add_u32 s47, s47, 116736
    v_add_u32 v8, s47, v3
    s_xor_b32 s47, s43, 4
    s_lshl_b32 s47, s47, 12
    s_add_u32 s47, s47, 116736
    v_add_u32 v10, s47, v3
    v_mul_u32_u24 v11, 896, v5
    v_lshl_add_u32 v11, v2, 3, v11
    s_lshl_b32 s47, s45, 7
    s_lshl_b32 s48, s51, 6
    s_add_u32 s47, s47, s48
    v_add_u32 v11, s47, v11
    s_mov_b32 s70, 0
    s_nop 0
    s_branch L_oc_20
L_o_19:
    s_mov_b32 s71, 0
    s_waitcnt vmcnt(8)
    buffer_load_dwordx4 v[16:19], v4, s[16:19], s71 offen offset:0 sc1
    s_waitcnt vmcnt(8)
    buffer_load_dwordx4 v[20:23], v4, s[16:19], s71 offen offset:1024 sc1
    s_waitcnt vmcnt(8)
    buffer_load_dwordx4 v[24:27], v4, s[16:19], s71 offen offset:2048 sc1
    s_waitcnt vmcnt(8)
    buffer_load_dwordx4 v[28:31], v4, s[16:19], s71 offen offset:3072 sc1
    s_waitcnt vmcnt(8)
    buffer_load_dwordx4 v[32:35], v7, s[16:19], s71 offen offset:0 sc1
    s_waitcnt vmcnt(8)
    buffer_load_dwordx4 v[36:39], v7, s[16:19], s71 offen offset:1024 sc1
    s_waitcnt vmcnt(8)
    buffer_load_dwordx4 v[40:43], v7, s[16:19], s71 offen offset:2048 sc1
    s_waitcnt vmcnt(8)
    buffer_load_dwordx4 v[44:47], v7, s[16:19], s71 offen offset:3072 sc1
    s_waitcnt vmcnt(8)
    buffer_load_dword v6, v9, s[16:19], 0 offen sc1
L_oc_20:
    s_waitcnt vmcnt(0)
    v_max_u32 v144, v16, v17
    v_max3_u32 v144, v144, v18, v19
    v_max3_u32 v144, v144, v20, v21
    v_max3_u32 v144, v144, v22, v23
    v_max3_u32 v144, v144, v24, v25
    v_max3_u32 v144, v144, v26, v27
    v_max3_u32 v144, v144, v28, v29
    v_max3_u32 v144, v144, v30, v31
    v_max3_u32 v144, v144, v32, v33
    v_max3_u32 v144, v144, v34, v35
    v_max3_u32 v144, v144, v36, v37
    v_max3_u32 v144, v144, v38, v39
    v_max3_u32 v144, v144, v40, v41
    v_max3_u32 v144, v144, v42, v43
    v_max3_u32 v144, v144, v44, v45
    v_max3_u32 v144, v144, v46, v47
    v_max_u32 v144, v144, v6
    v_cmp_eq_u32 vcc, -1, v144
    s_nop 0
    s_cbranch_vccz L_od_21
    s_add_u32 s70, s70, 1
    s_cmp_lt_u32 s70, 30000
    s_cbranch_scc0 L_od_21
    s_sleep 2
    s_branch L_o_19
L_od_21:
    ds_read_b64_tr_b16 v[112:113], v12 offset:0
    ds_read_b64_tr_b16 v[114:115], v12 offset:2048
    ds_read_b64_tr_b16 v[116:117], v13 offset:0
    ds_read_b64_tr_b16 v[118:119], v13 offset:2048
    ds_read_b64_tr_b16 v[120:121], v14 offset:0
    ds_read_b64_tr_b16 v[122:123], v14 offset:2048
    ds_read_b64_tr_b16 v[124:125], v15 offset:0
    ds_read_b64_tr_b16 v[126:127], v15 offset:2048
    ds_read_b64_tr_b16 v[128:129], v14 offset:3584
    ds_read_b64_tr_b16 v[130:131], v14 offset:5632
    ds_read_b64_tr_b16 v[132:133], v15 offset:3584
    s_waitcnt lgkmcnt(5)
    v_mfma_f32_16x16x32_bf16 v[88:91], v[120:123], v[16:19], 0
    ds_read_b64_tr_b16 v[134:135], v15 offset:5632
    ds_read_b64_tr_b16 v[136:137], v12 offset:3584
    ds_read_b64_tr_b16 v[138:139], v12 offset:5632
    s_waitcnt lgkmcnt(6)
    v_mfma_f32_16x16x32_bf16 v[92:95], v[124:127], v[16:19], 0
    ds_read_b64_tr_b16 v[140:141], v13 offset:3584
    ds_read_b64_tr_b16 v[142:143], v13 offset:5632
    v_mfma_f32_16x16x32_bf16 v[80:83], v[112:115], v[16:19], 0
    v_mfma_f32_16x16x32_bf16 v[84:87], v[116:119], v[16:19], 0
    ds_read_b64_tr_b16 v[112:113], v12 offset:7168
    ds_read_b64_tr_b16 v[114:115], v12 offset:9216
    ds_read_b64_tr_b16 v[116:117], v13 offset:7168
    s_waitcnt lgkmcnt(5)
    v_mfma_f32_16x16x32_bf16 v[88:91], v[136:139], v[20:23], v[88:91]
    ds_read_b64_tr_b16 v[118:119], v13 offset:9216
    ds_read_b64_tr_b16 v[120:121], v14 offset:7168
    ds_read_b64_tr_b16 v[122:123], v14 offset:9216
    s_waitcnt lgkmcnt(6)
    v_mfma_f32_16x16x32_bf16 v[92:95], v[140:143], v[20:23], v[92:95]
    ds_read_b64_tr_b16 v[124:125], v15 offset:7168
    ds_read_b64_tr_b16 v[126:127], v15 offset:9216
    v_mfma_f32_16x16x32_bf16 v[80:83], v[128:131], v[20:23], v[80:83]
    v_mfma_f32_16x16x32_bf16 v[84:87], v[132:135], v[20:23], v[84:87]
    ds_read_b64_tr_b16 v[128:129], v14 offset:10752
    ds_read_b64_tr_b16 v[130:131], v14 offset:12800
    ds_read_b64_tr_b16 v[132:133], v15 offset:10752
    s_waitcnt lgkmcnt(5)
    v_mfma_f32_16x16x32_bf16 v[88:91], v[120:123], v[24:27], v[88:91]
    ds_read_b64_tr_b16 v[134:135], v15 offset:12800
    ds_read_b64_tr_b16 v[136:137], v12 offset:10752
    ds_read_b64_tr_b16 v[138:139], v12 offset:12800
    s_waitcnt lgkmcnt(6)
    v_mfma_f32_16x16x32_bf16 v[92:95], v[124:127], v[24:27], v[92:95]
    ds_read_b64_tr_b16 v[140:141], v13 offset:10752
    ds_read_b64_tr_b16 v[142:143], v13 offset:12800
    v_mfma_f32_16x16x32_bf16 v[80:83], v[112:115], v[24:27], v[80:83]
    v_mfma_f32_16x16x32_bf16 v[84:87], v[116:119], v[24:27], v[84:87]
    ds_read_b64_tr_b16 v[112:113], v12 offset:14336
    ds_read_b64_tr_b16 v[114:115], v12 offset:16384
    ds_read_b64_tr_b16 v[116:117], v13 offset:14336
    s_waitcnt lgkmcnt(5)
    v_mfma_f32_16x16x32_bf16 v[88:91], v[136:139], v[28:31], v[88:91]
    ds_read_b64_tr_b16 v[118:119], v13 offset:16384
    ds_read_b64_tr_b16 v[120:121], v14 offset:14336
    ds_read_b64_tr_b16 v[122:123], v14 offset:16384
    s_waitcnt lgkmcnt(6)
    v_mfma_f32_16x16x32_bf16 v[92:95], v[140:143], v[28:31], v[92:95]
    ds_read_b64_tr_b16 v[124:125], v15 offset:14336
    ds_read_b64_tr_b16 v[126:127], v15 offset:16384
    v_mfma_f32_16x16x32_bf16 v[80:83], v[128:131], v[28:31], v[80:83]
    v_mfma_f32_16x16x32_bf16 v[84:87], v[132:135], v[28:31], v[84:87]
    ds_read_b64_tr_b16 v[128:129], v14 offset:17920
    ds_read_b64_tr_b16 v[130:131], v14 offset:19968
    ds_read_b64_tr_b16 v[132:133], v15 offset:17920
    s_waitcnt lgkmcnt(5)
    v_mfma_f32_16x16x32_bf16 v[88:91], v[120:123], v[32:35], v[88:91]
    ds_read_b64_tr_b16 v[134:135], v15 offset:19968
    ds_read_b64_tr_b16 v[136:137], v12 offset:17920
    ds_read_b64_tr_b16 v[138:139], v12 offset:19968
    s_waitcnt lgkmcnt(6)
    v_mfma_f32_16x16x32_bf16 v[92:95], v[124:127], v[32:35], v[92:95]
    ds_read_b64_tr_b16 v[140:141], v13 offset:17920
    ds_read_b64_tr_b16 v[142:143], v13 offset:19968
    v_mfma_f32_16x16x32_bf16 v[80:83], v[112:115], v[32:35], v[80:83]
    v_mfma_f32_16x16x32_bf16 v[84:87], v[116:119], v[32:35], v[84:87]
    ds_read_b64_tr_b16 v[112:113], v12 offset:21504
    ds_read_b64_tr_b16 v[114:115], v12 offset:23552
    ds_read_b64_tr_b16 v[116:117], v13 offset:21504
    s_waitcnt lgkmcnt(5)
    v_mfma_f32_16x16x32_bf16 v[88:91], v[136:139], v[36:39], v[88:91]
    ds_read_b64_tr_b16 v[118:119], v13 offset:23552
    ds_read_b64_tr_b16 v[120:121], v14 offset:21504
    ds_read_b64_tr_b16 v[122:123], v14 offset:23552
    s_waitcnt lgkmcnt(6)
    v_mfma_f32_16x16x32_bf16 v[92:95], v[140:143], v[36:39], v[92:95]
    ds_read_b64_tr_b16 v[124:125], v15 offset:21504
    ds_read_b64_tr_b16 v[126:127], v15 offset:23552
    v_mfma_f32_16x16x32_bf16 v[80:83], v[128:131], v[36:39], v[80:83]
    v_mfma_f32_16x16x32_bf16 v[84:87], v[132:135], v[36:39], v[84:87]
    ds_read_b64_tr_b16 v[128:129], v14 offset:25088
    ds_read_b64_tr_b16 v[130:131], v14 offset:27136
    ds_read_b64_tr_b16 v[132:133], v15 offset:25088
    s_waitcnt lgkmcnt(5)
    v_mfma_f32_16x16x32_bf16 v[88:91], v[120:123], v[40:43], v[88:91]
    ds_read_b64_tr_b16 v[134:135], v15 offset:27136
    ds_read_b64_tr_b16 v[136:137], v12 offset:25088
    ds_read_b64_tr_b16 v[138:139], v12 offset:27136
    s_waitcnt lgkmcnt(6)
    v_mfma_f32_16x16x32_bf16 v[92:95], v[124:127], v[40:43], v[92:95]
    ds_read_b64_tr_b16 v[140:141], v13 offset:25088
    ds_read_b64_tr_b16 v[142:143], v13 offset:27136
    v_mfma_f32_16x16x32_bf16 v[80:83], v[112:115], v[40:43], v[80:83]
    v_mfma_f32_16x16x32_bf16 v[84:87], v[116:119], v[40:43], v[84:87]
    s_waitcnt lgkmcnt(2)
    v_mfma_f32_16x16x32_bf16 v[88:91], v[136:139], v[44:47], v[88:91]
    s_waitcnt lgkmcnt(0)
    v_mfma_f32_16x16x32_bf16 v[92:95], v[140:143], v[44:47], v[92:95]
    v_mfma_f32_16x16x32_bf16 v[80:83], v[128:131], v[44:47], v[80:83]
    v_mfma_f32_16x16x32_bf16 v[84:87], v[132:135], v[44:47], v[84:87]
    s_nop 3
    ds_write_b128 v8, v[88:91] offset:0
    s_nop 0
    ds_write_b128 v8, v[92:95] offset:1024
    s_mov_b32 s71, 2097152
    buffer_load_dwordx4 v[48:51], v4, s[16:19], s71 offen offset:0 sc1
    buffer_load_dwordx4 v[52:55], v4, s[16:19], s71 offen offset:1024 sc1
    buffer_load_dwordx4 v[56:59], v4, s[16:19], s71 offen offset:2048 sc1
    buffer_load_dwordx4 v[60:63], v4, s[16:19], s71 offen offset:3072 sc1
    buffer_load_dwordx4 v[64:67], v7, s[16:19], s71 offen offset:0 sc1
    buffer_load_dwordx4 v[68:71], v7, s[16:19], s71 offen offset:1024 sc1
    buffer_load_dwordx4 v[72:75], v7, s[16:19], s71 offen offset:2048 sc1
    buffer_load_dwordx4 v[76:79], v7, s[16:19], s71 offen offset:3072 sc1
    v_add_u32 v12, 0xffff1c00, v12
    v_add_u32 v13, 0xffff1c00, v13
    v_add_u32 v14, 0xffff1c00, v14
    v_add_u32 v15, 0xffff1c00, v15
    s_waitcnt lgkmcnt(0)
    s_barrier
    ds_read_b128 v[16:19], v10 offset:0
    ds_read_b128 v[20:23], v10 offset:1024
    v_sub_f32 v40, 1.0, v6
    v_cvt_pk_bf16_f32 v41, v40, v40
    v_lshlrev_b32 v40, 16, v41
    s_waitcnt lgkmcnt(1)
    v_add_f32 v24, v80, v16
    v_add_f32 v25, v81, v17
    v_add_f32 v26, v82, v18
    v_add_f32 v27, v83, v19
    s_waitcnt lgkmcnt(0)
    v_add_f32 v28, v84, v20
    v_add_f32 v29, v85, v21
    v_add_f32 v30, v86, v22
    v_add_f32 v31, v87, v23
    v_cvt_pk_bf16_f32 v32, v24, v25
    v_cvt_pk_bf16_f32 v33, v26, v27
    v_cvt_pk_bf16_f32 v34, v28, v29
    v_cvt_pk_bf16_f32 v35, v30, v31
    v_lshlrev_b32 v24, 16, v32
    v_and_b32 v25, s67, v32
    v_lshlrev_b32 v26, 16, v33
    v_and_b32 v27, s67, v33
    v_lshlrev_b32 v28, 16, v34
    v_and_b32 v29, s67, v34
    v_lshlrev_b32 v30, 16, v35
    v_and_b32 v31, s67, v35
    v_mul_f32 v24, v24, v6
    v_mul_f32 v25, v25, v6
    v_mul_f32 v26, v26, v6
    v_mul_f32 v27, v27, v6
    v_mul_f32 v28, v28, v6
    v_mul_f32 v29, v29, v6
    v_mul_f32 v30, v30, v6
    v_mul_f32 v31, v31, v6
    v_cvt_pk_bf16_f32 v32, v24, v25
    v_cvt_pk_bf16_f32 v33, v26, v27
    v_cvt_pk_bf16_f32 v34, v28, v29
    v_cvt_pk_bf16_f32 v35, v30, v31
    v_lshlrev_b32 v24, 16, v32
    v_and_b32 v25, s67, v32
    v_lshlrev_b32 v26, 16, v33
    v_and_b32 v27, s67, v33
    v_lshlrev_b32 v28, 16, v34
    v_and_b32 v29, s67, v34
    v_lshlrev_b32 v30, 16, v35
    v_and_b32 v31, s67, v35
    s_mov_b32 s70, 0
    s_nop 0
    s_branch L_oc_23
L_o_22:
    s_mov_b32 s71, 2097152
    s_waitcnt vmcnt(7)
    buffer_load_dwordx4 v[48:51], v4, s[16:19], s71 offen offset:0 sc1
    s_waitcnt vmcnt(7)
    buffer_load_dwordx4 v[52:55], v4, s[16:19], s71 offen offset:1024 sc1
    s_waitcnt vmcnt(7)
    buffer_load_dwordx4 v[56:59], v4, s[16:19], s71 offen offset:2048 sc1
    s_waitcnt vmcnt(7)
    buffer_load_dwordx4 v[60:63], v4, s[16:19], s71 offen offset:3072 sc1
    s_waitcnt vmcnt(7)
    buffer_load_dwordx4 v[64:67], v7, s[16:19], s71 offen offset:0 sc1
    s_waitcnt vmcnt(7)
    buffer_load_dwordx4 v[68:71], v7, s[16:19], s71 offen offset:1024 sc1
    s_waitcnt vmcnt(7)
    buffer_load_dwordx4 v[72:75], v7, s[16:19], s71 offen offset:2048 sc1
    s_waitcnt vmcnt(7)
    buffer_load_dwordx4 v[76:79], v7, s[16:19], s71 offen offset:3072 sc1
L_oc_23:
    s_waitcnt vmcnt(0)
    v_max_u32 v144, v48, v49
    v_max3_u32 v144, v144, v50, v51
    v_max3_u32 v144, v144, v52, v53
    v_max3_u32 v144, v144, v54, v55
    v_max3_u32 v144, v144, v56, v57
    v_max3_u32 v144, v144, v58, v59
    v_max3_u32 v144, v144, v60, v61
    v_max3_u32 v144, v144, v62, v63
    v_max3_u32 v144, v144, v64, v65
    v_max3_u32 v144, v144, v66, v67
    v_max3_u32 v144, v144, v68, v69
    v_max3_u32 v144, v144, v70, v71
    v_max3_u32 v144, v144, v72, v73
    v_max3_u32 v144, v144, v74, v75
    v_max3_u32 v144, v144, v76, v77
    v_max3_u32 v144, v144, v78, v79
    v_cmp_eq_u32 vcc, -1, v144
    s_nop 0
    s_cbranch_vccz L_od_24
    s_add_u32 s70, s70, 1
    s_cmp_lt_u32 s70, 30000
    s_cbranch_scc0 L_od_24
    s_sleep 2
    s_branch L_o_22
L_od_24:
    ds_read_b64_tr_b16 v[112:113], v12 offset:0
    ds_read_b64_tr_b16 v[114:115], v12 offset:2048
    ds_read_b64_tr_b16 v[116:117], v13 offset:0
    ds_read_b64_tr_b16 v[118:119], v13 offset:2048
    ds_read_b64_tr_b16 v[120:121], v14 offset:0
    ds_read_b64_tr_b16 v[122:123], v14 offset:2048
    ds_read_b64_tr_b16 v[124:125], v15 offset:0
    ds_read_b64_tr_b16 v[126:127], v15 offset:2048
    ds_read_b64_tr_b16 v[128:129], v14 offset:3584
    ds_read_b64_tr_b16 v[130:131], v14 offset:5632
    ds_read_b64_tr_b16 v[132:133], v15 offset:3584
    s_waitcnt lgkmcnt(5)
    v_mfma_f32_16x16x32_bf16 v[104:107], v[120:123], v[48:51], 0
    ds_read_b64_tr_b16 v[134:135], v15 offset:5632
    ds_read_b64_tr_b16 v[136:137], v12 offset:3584
    ds_read_b64_tr_b16 v[138:139], v12 offset:5632
    s_waitcnt lgkmcnt(6)
    v_mfma_f32_16x16x32_bf16 v[108:111], v[124:127], v[48:51], 0
    ds_read_b64_tr_b16 v[140:141], v13 offset:3584
    ds_read_b64_tr_b16 v[142:143], v13 offset:5632
    v_mfma_f32_16x16x32_bf16 v[96:99], v[112:115], v[48:51], 0
    v_mfma_f32_16x16x32_bf16 v[100:103], v[116:119], v[48:51], 0
    ds_read_b64_tr_b16 v[112:113], v12 offset:7168
    ds_read_b64_tr_b16 v[114:115], v12 offset:9216
    ds_read_b64_tr_b16 v[116:117], v13 offset:7168
    s_waitcnt lgkmcnt(5)
    v_mfma_f32_16x16x32_bf16 v[104:107], v[136:139], v[52:55], v[104:107]
    ds_read_b64_tr_b16 v[118:119], v13 offset:9216
    ds_read_b64_tr_b16 v[120:121], v14 offset:7168
    ds_read_b64_tr_b16 v[122:123], v14 offset:9216
    s_waitcnt lgkmcnt(6)
    v_mfma_f32_16x16x32_bf16 v[108:111], v[140:143], v[52:55], v[108:111]
    ds_read_b64_tr_b16 v[124:125], v15 offset:7168
    ds_read_b64_tr_b16 v[126:127], v15 offset:9216
    v_mfma_f32_16x16x32_bf16 v[96:99], v[128:131], v[52:55], v[96:99]
    v_mfma_f32_16x16x32_bf16 v[100:103], v[132:135], v[52:55], v[100:103]
    ds_read_b64_tr_b16 v[128:129], v14 offset:10752
    ds_read_b64_tr_b16 v[130:131], v14 offset:12800
    ds_read_b64_tr_b16 v[132:133], v15 offset:10752
    s_waitcnt lgkmcnt(5)
    v_mfma_f32_16x16x32_bf16 v[104:107], v[120:123], v[56:59], v[104:107]
    ds_read_b64_tr_b16 v[134:135], v15 offset:12800
    ds_read_b64_tr_b16 v[136:137], v12 offset:10752
    ds_read_b64_tr_b16 v[138:139], v12 offset:12800
    s_waitcnt lgkmcnt(6)
    v_mfma_f32_16x16x32_bf16 v[108:111], v[124:127], v[56:59], v[108:111]
    ds_read_b64_tr_b16 v[140:141], v13 offset:10752
    ds_read_b64_tr_b16 v[142:143], v13 offset:12800
    v_mfma_f32_16x16x32_bf16 v[96:99], v[112:115], v[56:59], v[96:99]
    v_mfma_f32_16x16x32_bf16 v[100:103], v[116:119], v[56:59], v[100:103]
    ds_read_b64_tr_b16 v[112:113], v12 offset:14336
    ds_read_b64_tr_b16 v[114:115], v12 offset:16384
    ds_read_b64_tr_b16 v[116:117], v13 offset:14336
    s_waitcnt lgkmcnt(5)
    v_mfma_f32_16x16x32_bf16 v[104:107], v[136:139], v[60:63], v[104:107]
    ds_read_b64_tr_b16 v[118:119], v13 offset:16384
    ds_read_b64_tr_b16 v[120:121], v14 offset:14336
    ds_read_b64_tr_b16 v[122:123], v14 offset:16384
    s_waitcnt lgkmcnt(6)
    v_mfma_f32_16x16x32_bf16 v[108:111], v[140:143], v[60:63], v[108:111]
    ds_read_b64_tr_b16 v[124:125], v15 offset:14336
    ds_read_b64_tr_b16 v[126:127], v15 offset:16384
    v_mfma_f32_16x16x32_bf16 v[96:99], v[128:131], v[60:63], v[96:99]
    v_mfma_f32_16x16x32_bf16 v[100:103], v[132:135], v[60:63], v[100:103]
    ds_read_b64_tr_b16 v[128:129], v14 offset:17920
    ds_read_b64_tr_b16 v[130:131], v14 offset:19968
    ds_read_b64_tr_b16 v[132:133], v15 offset:17920
    s_waitcnt lgkmcnt(5)
    v_mfma_f32_16x16x32_bf16 v[104:107], v[120:123], v[64:67], v[104:107]
    ds_read_b64_tr_b16 v[134:135], v15 offset:19968
    ds_read_b64_tr_b16 v[136:137], v12 offset:17920
    ds_read_b64_tr_b16 v[138:139], v12 offset:19968
    s_waitcnt lgkmcnt(6)
    v_mfma_f32_16x16x32_bf16 v[108:111], v[124:127], v[64:67], v[108:111]
    ds_read_b64_tr_b16 v[140:141], v13 offset:17920
    ds_read_b64_tr_b16 v[142:143], v13 offset:19968
    v_mfma_f32_16x16x32_bf16 v[96:99], v[112:115], v[64:67], v[96:99]
    v_mfma_f32_16x16x32_bf16 v[100:103], v[116:119], v[64:67], v[100:103]
    ds_read_b64_tr_b16 v[112:113], v12 offset:21504
    ds_read_b64_tr_b16 v[114:115], v12 offset:23552
    ds_read_b64_tr_b16 v[116:117], v13 offset:21504
    s_waitcnt lgkmcnt(5)
    v_mfma_f32_16x16x32_bf16 v[104:107], v[136:139], v[68:71], v[104:107]
    ds_read_b64_tr_b16 v[118:119], v13 offset:23552
    ds_read_b64_tr_b16 v[120:121], v14 offset:21504
    ds_read_b64_tr_b16 v[122:123], v14 offset:23552
    s_waitcnt lgkmcnt(6)
    v_mfma_f32_16x16x32_bf16 v[108:111], v[140:143], v[68:71], v[108:111]
    ds_read_b64_tr_b16 v[124:125], v15 offset:21504
    ds_read_b64_tr_b16 v[126:127], v15 offset:23552
    v_mfma_f32_16x16x32_bf16 v[96:99], v[128:131], v[68:71], v[96:99]
    v_mfma_f32_16x16x32_bf16 v[100:103], v[132:135], v[68:71], v[100:103]
    ds_read_b64_tr_b16 v[128:129], v14 offset:25088
    ds_read_b64_tr_b16 v[130:131], v14 offset:27136
    ds_read_b64_tr_b16 v[132:133], v15 offset:25088
    s_waitcnt lgkmcnt(5)
    v_mfma_f32_16x16x32_bf16 v[104:107], v[120:123], v[72:75], v[104:107]
    ds_read_b64_tr_b16 v[134:135], v15 offset:27136
    ds_read_b64_tr_b16 v[136:137], v12 offset:25088
    ds_read_b64_tr_b16 v[138:139], v12 offset:27136
    s_waitcnt lgkmcnt(6)
    v_mfma_f32_16x16x32_bf16 v[108:111], v[124:127], v[72:75], v[108:111]
    ds_read_b64_tr_b16 v[140:141], v13 offset:25088
    ds_read_b64_tr_b16 v[142:143], v13 offset:27136
    v_mfma_f32_16x16x32_bf16 v[96:99], v[112:115], v[72:75], v[96:99]
    v_mfma_f32_16x16x32_bf16 v[100:103], v[116:119], v[72:75], v[100:103]
    s_waitcnt lgkmcnt(2)
    v_mfma_f32_16x16x32_bf16 v[104:107], v[136:139], v[76:79], v[104:107]
    s_waitcnt lgkmcnt(0)
    v_mfma_f32_16x16x32_bf16 v[108:111], v[140:143], v[76:79], v[108:111]
    v_mfma_f32_16x16x32_bf16 v[96:99], v[128:131], v[76:79], v[96:99]
    v_mfma_f32_16x16x32_bf16 v[100:103], v[132:135], v[76:79], v[100:103]
    s_nop 3
    ds_write_b128 v8, v[104:107] offset:2048
    s_nop 0
    ds_write_b128 v8, v[108:111] offset:3072
    s_waitcnt lgkmcnt(0)
    s_barrier
    ds_read_b128 v[16:19], v10 offset:2048
    ds_read_b128 v[20:23], v10 offset:3072
    s_waitcnt lgkmcnt(1)
    v_add_f32 v96, v96, v16
    v_add_f32 v97, v97, v17
    v_add_f32 v98, v98, v18
    v_add_f32 v99, v99, v19
    s_waitcnt lgkmcnt(0)
    v_add_f32 v100, v100, v20
    v_add_f32 v101, v101, v21
    v_add_f32 v102, v102, v22
    v_add_f32 v103, v103, v23
    v_cvt_pk_bf16_f32 v32, v96, v97
    v_cvt_pk_bf16_f32 v33, v98, v99
    v_cvt_pk_bf16_f32 v34, v100, v101
    v_cvt_pk_bf16_f32 v35, v102, v103
    v_lshlrev_b32 v96, 16, v32
    v_and_b32 v97, s67, v32
    v_lshlrev_b32 v98, 16, v33
    v_and_b32 v99, s67, v33
    v_lshlrev_b32 v100, 16, v34
    v_and_b32 v101, s67, v34
    v_lshlrev_b32 v102, 16, v35
    v_and_b32 v103, s67, v35
    v_mul_f32 v96, v96, v40
    v_mul_f32 v97, v97, v40
    v_mul_f32 v98, v98, v40
    v_mul_f32 v99, v99, v40
    v_mul_f32 v100, v100, v40
    v_mul_f32 v101, v101, v40
    v_mul_f32 v102, v102, v40
    v_mul_f32 v103, v103, v40
    v_cvt_pk_bf16_f32 v32, v96, v97
    v_cvt_pk_bf16_f32 v33, v98, v99
    v_cvt_pk_bf16_f32 v34, v100, v101
    v_cvt_pk_bf16_f32 v35, v102, v103
    v_lshlrev_b32 v96, 16, v32
    v_and_b32 v97, s67, v32
    v_lshlrev_b32 v98, 16, v33
    v_and_b32 v99, s67, v33
    v_lshlrev_b32 v100, 16, v34
    v_and_b32 v101, s67, v34
    v_lshlrev_b32 v102, 16, v35
    v_and_b32 v103, s67, v35
    v_add_f32 v24, v24, v96
    v_add_f32 v25, v25, v97
    v_add_f32 v26, v26, v98
    v_add_f32 v27, v27, v99
    v_add_f32 v28, v28, v100
    v_add_f32 v29, v29, v101
    v_add_f32 v30, v30, v102
    v_add_f32 v31, v31, v103
    v_cvt_pk_bf16_f32 v32, v24, v25
    v_cvt_pk_bf16_f32 v33, v26, v27
    v_cvt_pk_bf16_f32 v34, v28, v29
    v_cvt_pk_bf16_f32 v35, v30, v31
    buffer_store_dwordx2 v[32:33], v11, s[36:39], 0 offen offset:0
    buffer_store_dwordx2 v[34:35], v11, s[36:39], 0 offen offset:32
L_fin:
L_end:
    s_endpgm
.section .rodata,"a"
.p2align 6
.amdhsa_kernel gated_mix__sliding_local_dilated__linear_kernel_hedgehog__prompt_kernel
  .amdhsa_next_free_vgpr 168
  .amdhsa_next_free_sgpr 102
  .amdhsa_accum_offset 168
  .amdhsa_group_segment_fixed_size 0
  .amdhsa_kernarg_size 88
  .amdhsa_user_sgpr_count 2
  .amdhsa_user_sgpr_kernarg_segment_ptr 1
  .amdhsa_system_sgpr_workgroup_id_x 1
.end_amdhsa_kernel
```
